```python
import torch

def _softmax(x, axis=-1):
    return torch.softmax(x, dim=axis)
def _gelu(x):
    return torch.nn.functional.gelu(x, approximate="tanh")
def _silu(x):
    return torch.nn.functional.silu(x)
def _sigmoid(x):
    return torch.sigmoid(x)
def _layernorm(x, axis=-1, eps=1e-5):
    m = x.mean(dim=axis, keepdim=True)
    v = x.var(dim=axis, keepdim=True, unbiased=False)
    return (x - m) / torch.sqrt(v + eps)
def _scatter_add(tgt, idx, src, axis=0):
    return tgt.clone().index_add_(axis, idx, src)
def _segment_sum(src, seg, n):
    out = torch.zeros((n,) + src.shape[1:], dtype=src.dtype)
    return out.index_add_(0, seg, src)
def _pad(x, pw):
    flat = tuple(v for pair in reversed(pw) for v in pair)
    return torch.nn.functional.pad(x, flat)

kernel_name = 'concat_heads__softmax_full_mha__linear_attn_block__prompt'

def setup_inputs():

    _w = (lambda a: (lambda t: t.to(torch.bfloat16) if t.is_floating_point() else t)(torch.as_tensor(a)))
    def _A_setup():
        B, S, D = 1, 2048, 512
        return {
            "x": _w((lambda *s: torch.randn(*s, dtype=torch.bfloat16) * 0.2)(B, S, D)),
            "wqkv": _w((lambda *s: torch.randn(*s, dtype=torch.bfloat16) * 0.2)(D, 3 * D)),
            "wo": _w((lambda *s: torch.randn(*s, dtype=torch.bfloat16) * 0.05)(D, D)),
        }
    _A_in = _A_setup()

    def _B_setup():
        B, S, D = 1, 2048, 512
        return {
            "x": _w((lambda *s: torch.randn(*s, dtype=torch.bfloat16) * 0.05)(B, S, D)),
            "wqkv": _w((lambda *s: torch.randn(*s, dtype=torch.bfloat16) * 1.6)(D, 3 * D)),
            "wo": _w((lambda *s: torch.randn(*s, dtype=torch.bfloat16) * 0.05)(D, D)),
        }
    _B_in = _B_setup()

    return {
        "A_x": _A_in["x"],
        "A_wqkv": _A_in["wqkv"],
        "A_wo": _A_in["wo"],
        "B_x": _B_in["x"],
        "B_wqkv": _B_in["wqkv"],
        "B_wo": _B_in["wo"],
    }

def reference(A_x, A_wqkv, A_wo, B_x, B_wqkv, B_wo):
    def _A_ref(x, wqkv, wo):
        B, S, D = x.shape
        H = 32; Dh = D // H
        qkv = (lambda x, *d: x.permute(*d))((x @ wqkv).reshape(B, S, 3, H, Dh), 2, 0, 3, 1, 4)
        q, k, v = qkv[0], qkv[1], qkv[2]
        scale = Dh ** -0.5
        scores = torch.einsum("bhqd,bhkd->bhqk", q, k) * scale
        p = _softmax(scores, axis=-1)
        o = torch.einsum("bhqk,bhkd->bhqd", p, v)
        return (lambda x, *d: x.permute(*d))(o, 0, 2, 1, 3).reshape(B, S, D) @ wo

    def _B_ref(x, wqkv, wo):
        B, S, D = x.shape
        H = 32; Dh = D // H
        qkv = (lambda x, *d: x.permute(*d))((x @ wqkv).reshape(B, S, 3, H, Dh), 2, 0, 3, 1, 4)
        q, k, v = qkv[0], qkv[1], qkv[2]
        phi = lambda t: torch.where(t > 0, t + 1, torch.exp(t)) + 1e-6
        pq, pk = phi(q), phi(k)
        kv = torch.einsum("bhsd,bhse->bhde", pk, v)
        z = torch.einsum("bhsd->bhd", pk)
        num = torch.einsum("bhqd,bhde->bhqe", pq, kv)
        den = torch.einsum("bhqd,bhd->bhq", pq, z)[..., None] + 1e-6
        o = num / den
        return (lambda x, *d: x.permute(*d))(o, 0, 2, 1, 3).reshape(B, S, D) @ wo

    a = _A_ref(A_x, A_wqkv, A_wo)
    b = _B_ref(B_x, B_wqkv, B_wo)
    return torch.concatenate([a, b], axis=-1)
```

```asm
; @launch grid=(256,1,1) block=(512,1,1) lds=163840
.amdgcn_target "amdgcn-amd-amdhsa--gfx950"
.text
.globl concat_heads__softmax_full_mha__linear_attn_block__prompt_kernel
.p2align 8
.type concat_heads__softmax_full_mha__linear_attn_block__prompt_kernel,@function
concat_heads__softmax_full_mha__linear_attn_block__prompt_kernel:
    s_load_dwordx4 s[4:7], s[0:1], 0
    s_load_dwordx2 s[8:9], s[0:1], 24
    s_load_dwordx2 s[10:11], s[0:1], 32
    s_cmp_ge_u32 s2, 256
    s_cbranch_scc1 K_end
    v_lshrrev_b32 v1, 6, v0
    v_and_b32 v2, 63, v0
    v_readfirstlane_b32 s20, v1
    s_bfe_u32 s42, s2, 0x20003
    s_bfe_u32 s43, s2, 0x20005
    s_bfe_u32 s21, s2, 0x20001
    s_lshl_b32 s21, s21, 2
    s_add_u32 s21, s21, s42
    s_and_b32 s22, s2, 1
    s_lshl_b32 s22, s22, 2
    s_add_u32 s22, s22, s43
    s_cmp_lt_u32 s20, 4
    s_cbranch_scc1 K_compute
    s_add_u32 s23, s42, s43
    s_and_b32 s23, s23, 3
    s_lshr_b32 s40, s2, 5
    s_and_b32 s40, s40, 4
    s_add_u32 s23, s23, s40
    s_lshl_b32 s23, s23, 2
    s_lshr_b32 s23, 0x64200000, s23
    s_and_b32 s23, s23, 7
    s_sub_u32 s18, s20, 4
    v_bfe_u32 v5, v0, 3, 5
    v_lshrrev_b32 v6, 1, v5
    v_xor_b32 v7, v6, v0
    v_and_b32 v7, 7, v7
    v_lshlrev_b32 v7, 4, v7
    v_lshl_add_u32 v10, v5, 10, v7
    s_lshl_b32 s44, s18, 3
    v_add_u32 v5, s44, v5
    v_lshlrev_b32 v6, 2, v6
    v_xor_b32 v6, v6, v0
    v_and_b32 v7, 3, v0
    v_and_or_b32 v6, v6, 4, v7
    v_lshlrev_b32 v6, 4, v6
    s_movk_i32 s44, 3072
    v_mad_u32_u24 v11, v5, s44, v6
    s_lshl_b32 s44, s21, 17
    s_lshl_b32 s45, s22, 7
    s_lshl_b32 s46, s18, 10
    s_lshl_b32 s47, s18, 11
    s_mov_b32 s26, 2097152
    s_mov_b32 s27, 0x20000
    s_mov_b32 s30, 0x180000
    s_mov_b32 s31, 0x20000
    s_bitcmp1_b32 s2, 7
    s_waitcnt lgkmcnt(0)
    s_cselect_b32 s24, s8, s4
    s_cselect_b32 s25, s9, s5
    s_cselect_b32 s28, s10, s6
    s_cselect_b32 s29, s11, s7
    s_cbranch_scc1 K_bpre
K_go:
    s_mul_i32 s51, s23, 196608
    s_add_u32 s51, s51, s45
    s_lshl_b32 s50, s23, 7
    s_add_u32 s50, s50, s44
    s_add_u32 m0, s47, 57344
    s_nop 0
    buffer_load_dwordx4 v11, s[28:31], s51 offen lds
    s_add_u32 m0, s46, 40960
    s_nop 0
    buffer_load_dwordx4 v10, s[24:27], s50 offen lds
    s_add_u32 m0, s47, 65536
    s_add_u32 s51, s51, 1024
    buffer_load_dwordx4 v11, s[28:31], s51 offen lds
    s_add_u32 m0, s47, 73728
    s_add_u32 s51, s51, 1024
    buffer_load_dwordx4 v11, s[28:31], s51 offen lds
    s_add_u32 m0, s46, 45056
    s_add_u32 s50, s50, 32768
    buffer_load_dwordx4 v10, s[24:27], s50 offen lds
    s_add_u32 m0, s47, 58368
    s_add_u32 s51, s51, 22528
    buffer_load_dwordx4 v11, s[28:31], s51 offen lds
    s_add_u32 m0, s46, 49152
    s_add_u32 s50, s50, 32768
    buffer_load_dwordx4 v10, s[24:27], s50 offen lds
    s_add_u32 m0, s47, 66560
    s_add_u32 s51, s51, 1024
    buffer_load_dwordx4 v11, s[28:31], s51 offen lds
    s_add_u32 m0, s47, 74752
    s_add_u32 s51, s51, 1024
    buffer_load_dwordx4 v11, s[28:31], s51 offen lds
    s_add_u32 m0, s46, 53248
    s_add_u32 s50, s50, 32768
    buffer_load_dwordx4 v10, s[24:27], s50 offen lds
    s_add_u32 s23, s23, 1
    s_and_b32 s23, s23, 7
    s_bitcmp1_b32 s2, 7
    s_cbranch_scc1 K_pf2
K_nopf2:
    s_load_dwordx4 s[56:59], s[0:1], 48
    s_load_dwordx2 s[16:17], s[0:1], 64
    s_mul_i32 s51, s23, 196608
    s_add_u32 s51, s51, s45
    s_lshl_b32 s50, s23, 7
    s_add_u32 s50, s50, s44
    s_add_u32 m0, s47, 98304
    s_nop 0
    buffer_load_dwordx4 v11, s[28:31], s51 offen lds
    s_add_u32 m0, s46, 81920
    s_nop 0
    buffer_load_dwordx4 v10, s[24:27], s50 offen lds
    s_add_u32 m0, s47, 106496
    s_add_u32 s51, s51, 1024
    buffer_load_dwordx4 v11, s[28:31], s51 offen lds
    s_add_u32 m0, s47, 114688
    s_add_u32 s51, s51, 1024
    buffer_load_dwordx4 v11, s[28:31], s51 offen lds
    s_add_u32 m0, s46, 86016
    s_add_u32 s50, s50, 32768
    buffer_load_dwordx4 v10, s[24:27], s50 offen lds
    s_add_u32 m0, s47, 99328
    s_add_u32 s51, s51, 22528
    buffer_load_dwordx4 v11, s[28:31], s51 offen lds
    s_add_u32 m0, s46, 90112
    s_add_u32 s50, s50, 32768
    buffer_load_dwordx4 v10, s[24:27], s50 offen lds
    s_add_u32 m0, s47, 107520
    s_add_u32 s51, s51, 1024
    buffer_load_dwordx4 v11, s[28:31], s51 offen lds
    s_add_u32 m0, s47, 115712
    s_add_u32 s51, s51, 1024
    buffer_load_dwordx4 v11, s[28:31], s51 offen lds
    s_add_u32 m0, s46, 94208
    s_add_u32 s50, s50, 32768
    buffer_load_dwordx4 v10, s[24:27], s50 offen lds
    s_add_u32 s23, s23, 1
    s_and_b32 s23, s23, 7
    s_and_b32 s40, s2, 7
    s_lshl_b32 s60, s40, 2
    s_add_u32 s60, s60, s42
    s_lshr_b32 s61, s2, 5
    s_lshl_b32 s61, s61, 3
    s_add_u32 s61, s61, s20
    s_lshl_b32 s64, s2, 3
    s_add_u32 s64, s64, s20
    s_lshl_b32 s64, s64, 7
    s_lshr_b32 s70, s60, 2
    s_and_b32 s40, s70, 3
    s_lshl_b32 s40, s40, 8
    s_lshr_b32 s70, s70, 2
    s_lshl_b32 s70, s70, 3
    s_add_u32 s70, s70, s40
    s_and_b32 s40, s60, 2
    s_add_u32 s70, s70, s40
    v_lshlrev_b32 v1, 4, v2
    v_mov_b32 v176, 0
    s_mov_b32 s12, 0
    s_mov_b32 s13, 0
    s_waitcnt lgkmcnt(0)
    s_mov_b32 s32, s16
    s_mov_b32 s33, s17
    s_mov_b32 s34, 0x1000000
    s_mov_b32 s35, 0x20000
    s_lshr_b32 s40, s2, 5
    s_lshl_b32 s40, s40, 2
    v_and_b32 v6, 3, v2
    v_cmp_gt_u32 vcc, 32, v2
    v_add_u32 v6, s40, v6
    v_mov_b32 v7, 15990784
    v_cndmask_b32 v5, v6, v2, vcc
    v_mov_b32 v6, 15728640
    v_cndmask_b32 v14, v7, v6, vcc
    v_bfe_u32 v6, v5, 1, 2
    v_lshlrev_b32 v6, 6, v6
    v_bfe_u32 v7, v5, 3, 2
    v_lshl_add_u32 v6, v7, 4, v6
    v_and_b32 v7, 1, v5
    v_add3_u32 v6, v6, v7, s70
    v_lshl_add_u32 v14, v6, 7, v14
    v_and_b32 v6, 1, v2
    v_cmp_eq_u32 vcc, 0, v6
    v_mov_b32 v6, 1065369472
    s_add_u32 s40, s47, 135168
    v_cndmask_b32 v40, 0, v6, vcc
    v_mov_b32 v41, v40
    v_mov_b32 v42, v40
    v_mov_b32 v43, v40
    v_add_u32 v8, s40, v1
    v_mov_b32 v101, 0
    s_bitcmp1_b32 s2, 7
    s_cbranch_scc0 K_nowo
    v_lshl_or_b32 v32, v17, 16, v16
    v_lshl_or_b32 v33, v19, 16, v18
    v_lshl_or_b32 v34, v21, 16, v20
    v_lshl_or_b32 v35, v23, 16, v22
    v_lshl_or_b32 v36, v25, 16, v24
    v_lshl_or_b32 v37, v27, 16, v26
    v_lshl_or_b32 v38, v29, 16, v28
    v_lshl_or_b32 v39, v31, 16, v30
    s_add_u32 s40, s68, 0x80000
    buffer_store_dwordx4 v[32:35], v1, s[32:35], s68 offen sc1
    buffer_store_dwordx4 v[36:39], v1, s[32:35], s40 offen sc1
K_nowo:
    s_bitcmp1_b32 s2, 7
    s_cbranch_scc1 K_wb0
    s_waitcnt vmcnt(10)
K_wb0:
    s_waitcnt vmcnt(13)
    s_barrier
    s_mul_i32 s51, s23, 196608
    s_add_u32 s51, s51, s45
    s_lshl_b32 s50, s23, 7
    s_add_u32 s50, s50, s44
    s_add_u32 m0, s47, 139264
    s_nop 0
    buffer_load_dwordx4 v11, s[28:31], s51 offen lds
    s_add_u32 m0, s46, 122880
    s_nop 0
    buffer_load_dwordx4 v10, s[24:27], s50 offen lds
    s_add_u32 m0, s47, 147456
    s_add_u32 s51, s51, 1024
    buffer_load_dwordx4 v11, s[28:31], s51 offen lds
    s_add_u32 m0, s47, 155648
    s_add_u32 s51, s51, 1024
    buffer_load_dwordx4 v11, s[28:31], s51 offen lds
    s_add_u32 m0, s46, 126976
    s_add_u32 s50, s50, 32768
    buffer_load_dwordx4 v10, s[24:27], s50 offen lds
    s_add_u32 m0, s47, 140288
    s_add_u32 s51, s51, 22528
    buffer_load_dwordx4 v11, s[28:31], s51 offen lds
    s_add_u32 m0, s46, 131072
    s_add_u32 s50, s50, 32768
    buffer_load_dwordx4 v10, s[24:27], s50 offen lds
    s_add_u32 m0, s47, 148480
    s_add_u32 s51, s51, 1024
    buffer_load_dwordx4 v11, s[28:31], s51 offen lds
    s_add_u32 m0, s47, 156672
    s_add_u32 s51, s51, 1024
    buffer_load_dwordx4 v11, s[28:31], s51 offen lds
    s_add_u32 m0, s46, 135168
    s_add_u32 s50, s50, 32768
    buffer_load_dwordx4 v10, s[24:27], s50 offen lds
    s_add_u32 s23, s23, 1
    s_and_b32 s23, s23, 7
    s_bitcmp1_b32 s2, 7
    s_cbranch_scc1 K_wb1
    s_waitcnt vmcnt(10)
K_wb1:
    s_waitcnt vmcnt(12)
    s_barrier
    s_mul_i32 s51, s23, 196608
    s_add_u32 s51, s51, s45
    s_lshl_b32 s50, s23, 7
    s_add_u32 s50, s50, s44
    s_add_u32 m0, s47, 57344
    s_nop 0
    buffer_load_dwordx4 v11, s[28:31], s51 offen lds
    s_add_u32 m0, s46, 40960
    s_nop 0
    buffer_load_dwordx4 v10, s[24:27], s50 offen lds
    s_add_u32 m0, s47, 65536
    s_add_u32 s51, s51, 1024
    buffer_load_dwordx4 v11, s[28:31], s51 offen lds
    s_add_u32 m0, s47, 73728
    s_add_u32 s51, s51, 1024
    buffer_load_dwordx4 v11, s[28:31], s51 offen lds
    s_add_u32 m0, s46, 45056
    s_add_u32 s50, s50, 32768
    buffer_load_dwordx4 v10, s[24:27], s50 offen lds
    s_add_u32 m0, s47, 58368
    s_add_u32 s51, s51, 22528
    buffer_load_dwordx4 v11, s[28:31], s51 offen lds
    s_add_u32 m0, s46, 49152
    s_add_u32 s50, s50, 32768
    buffer_load_dwordx4 v10, s[24:27], s50 offen lds
    s_add_u32 m0, s47, 66560
    s_add_u32 s51, s51, 1024
    buffer_load_dwordx4 v11, s[28:31], s51 offen lds
    s_add_u32 m0, s47, 74752
    s_add_u32 s51, s51, 1024
    buffer_load_dwordx4 v11, s[28:31], s51 offen lds
    s_add_u32 m0, s46, 53248
    s_add_u32 s50, s50, 32768
    buffer_load_dwordx4 v10, s[24:27], s50 offen lds
    s_add_u32 s23, s23, 1
    s_and_b32 s23, s23, 7
    s_waitcnt vmcnt(10)
    s_barrier
    s_mul_i32 s51, s23, 196608
    s_add_u32 s51, s51, s45
    s_lshl_b32 s50, s23, 7
    s_add_u32 s50, s50, s44
    s_add_u32 m0, s47, 98304
    s_nop 0
    buffer_load_dwordx4 v11, s[28:31], s51 offen lds
    s_add_u32 m0, s46, 81920
    s_nop 0
    buffer_load_dwordx4 v10, s[24:27], s50 offen lds
    s_add_u32 m0, s47, 106496
    s_add_u32 s51, s51, 1024
    buffer_load_dwordx4 v11, s[28:31], s51 offen lds
    s_add_u32 m0, s47, 114688
    s_add_u32 s51, s51, 1024
    buffer_load_dwordx4 v11, s[28:31], s51 offen lds
    s_add_u32 m0, s46, 86016
    s_add_u32 s50, s50, 32768
    buffer_load_dwordx4 v10, s[24:27], s50 offen lds
    s_add_u32 m0, s47, 99328
    s_add_u32 s51, s51, 22528
    buffer_load_dwordx4 v11, s[28:31], s51 offen lds
    s_add_u32 m0, s46, 90112
    s_add_u32 s50, s50, 32768
    buffer_load_dwordx4 v10, s[24:27], s50 offen lds
    s_add_u32 m0, s47, 107520
    s_add_u32 s51, s51, 1024
    buffer_load_dwordx4 v11, s[28:31], s51 offen lds
    s_add_u32 m0, s47, 115712
    s_add_u32 s51, s51, 1024
    buffer_load_dwordx4 v11, s[28:31], s51 offen lds
    s_add_u32 m0, s46, 94208
    s_add_u32 s50, s50, 32768
    buffer_load_dwordx4 v10, s[24:27], s50 offen lds
    s_add_u32 s23, s23, 1
    s_and_b32 s23, s23, 7
    s_waitcnt vmcnt(10)
    s_barrier
    s_mul_i32 s51, s23, 196608
    s_add_u32 s51, s51, s45
    s_lshl_b32 s50, s23, 7
    s_add_u32 s50, s50, s44
    s_add_u32 m0, s47, 139264
    s_nop 0
    buffer_load_dwordx4 v11, s[28:31], s51 offen lds
    s_add_u32 m0, s46, 122880
    s_nop 0
    buffer_load_dwordx4 v10, s[24:27], s50 offen lds
    s_add_u32 m0, s47, 147456
    s_add_u32 s51, s51, 1024
    buffer_load_dwordx4 v11, s[28:31], s51 offen lds
    s_add_u32 m0, s47, 155648
    s_add_u32 s51, s51, 1024
    buffer_load_dwordx4 v11, s[28:31], s51 offen lds
    s_add_u32 m0, s46, 126976
    s_add_u32 s50, s50, 32768
    buffer_load_dwordx4 v10, s[24:27], s50 offen lds
    s_add_u32 m0, s47, 140288
    s_add_u32 s51, s51, 22528
    buffer_load_dwordx4 v11, s[28:31], s51 offen lds
    s_add_u32 m0, s46, 131072
    s_add_u32 s50, s50, 32768
    buffer_load_dwordx4 v10, s[24:27], s50 offen lds
    s_add_u32 m0, s47, 148480
    s_add_u32 s51, s51, 1024
    buffer_load_dwordx4 v11, s[28:31], s51 offen lds
    s_add_u32 m0, s47, 156672
    s_add_u32 s51, s51, 1024
    buffer_load_dwordx4 v11, s[28:31], s51 offen lds
    s_add_u32 m0, s46, 135168
    s_add_u32 s50, s50, 32768
    buffer_load_dwordx4 v10, s[24:27], s50 offen lds
    s_add_u32 s23, s23, 1
    s_and_b32 s23, s23, 7
    s_waitcnt vmcnt(10)
    s_barrier
    s_mul_i32 s51, s23, 196608
    s_add_u32 s51, s51, s45
    s_lshl_b32 s50, s23, 7
    s_add_u32 s50, s50, s44
    s_add_u32 m0, s47, 57344
    s_nop 0
    buffer_load_dwordx4 v11, s[28:31], s51 offen lds
    s_add_u32 m0, s46, 40960
    s_nop 0
    buffer_load_dwordx4 v10, s[24:27], s50 offen lds
    s_add_u32 m0, s47, 65536
    s_add_u32 s51, s51, 1024
    buffer_load_dwordx4 v11, s[28:31], s51 offen lds
    s_add_u32 m0, s47, 73728
    s_add_u32 s51, s51, 1024
    buffer_load_dwordx4 v11, s[28:31], s51 offen lds
    s_add_u32 m0, s46, 45056
    s_add_u32 s50, s50, 32768
    buffer_load_dwordx4 v10, s[24:27], s50 offen lds
    s_add_u32 m0, s47, 58368
    s_add_u32 s51, s51, 22528
    buffer_load_dwordx4 v11, s[28:31], s51 offen lds
    s_add_u32 m0, s46, 49152
    s_add_u32 s50, s50, 32768
    buffer_load_dwordx4 v10, s[24:27], s50 offen lds
    s_add_u32 m0, s47, 66560
    s_add_u32 s51, s51, 1024
    buffer_load_dwordx4 v11, s[28:31], s51 offen lds
    s_add_u32 m0, s47, 74752
    s_add_u32 s51, s51, 1024
    buffer_load_dwordx4 v11, s[28:31], s51 offen lds
    s_add_u32 m0, s46, 53248
    s_add_u32 s50, s50, 32768
    buffer_load_dwordx4 v10, s[24:27], s50 offen lds
    s_add_u32 s23, s23, 1
    s_and_b32 s23, s23, 7
    s_waitcnt vmcnt(10)
    s_barrier
    s_mul_i32 s51, s23, 196608
    s_add_u32 s51, s51, s45
    s_lshl_b32 s50, s23, 7
    s_add_u32 s50, s50, s44
    s_add_u32 m0, s47, 98304
    s_nop 0
    buffer_load_dwordx4 v11, s[28:31], s51 offen lds
    s_add_u32 m0, s46, 81920
    s_nop 0
    buffer_load_dwordx4 v10, s[24:27], s50 offen lds
    s_add_u32 m0, s47, 106496
    s_add_u32 s51, s51, 1024
    buffer_load_dwordx4 v11, s[28:31], s51 offen lds
    s_add_u32 m0, s47, 114688
    s_add_u32 s51, s51, 1024
    buffer_load_dwordx4 v11, s[28:31], s51 offen lds
    s_add_u32 m0, s46, 86016
    s_add_u32 s50, s50, 32768
    buffer_load_dwordx4 v10, s[24:27], s50 offen lds
    s_add_u32 m0, s47, 99328
    s_add_u32 s51, s51, 22528
    buffer_load_dwordx4 v11, s[28:31], s51 offen lds
    s_add_u32 m0, s46, 90112
    s_add_u32 s50, s50, 32768
    buffer_load_dwordx4 v10, s[24:27], s50 offen lds
    s_add_u32 m0, s47, 107520
    s_add_u32 s51, s51, 1024
    buffer_load_dwordx4 v11, s[28:31], s51 offen lds
    s_add_u32 m0, s47, 115712
    s_add_u32 s51, s51, 1024
    buffer_load_dwordx4 v11, s[28:31], s51 offen lds
    s_add_u32 m0, s46, 94208
    s_add_u32 s50, s50, 32768
    buffer_load_dwordx4 v10, s[24:27], s50 offen lds
    s_add_u32 s23, s23, 1
    s_and_b32 s23, s23, 7
    s_mov_b32 s36, s58
    s_mov_b32 s37, s59
    s_mov_b32 s38, 0x100
    s_mov_b32 s39, 0x20000
    buffer_load_dword v3, v101, s[36:39], 0 offen sc1
    s_waitcnt vmcnt(11)
    s_barrier
    s_waitcnt vmcnt(1)
    s_barrier
    s_bitcmp1_b32 s2, 7
    s_cbranch_scc0 K_nofl
    buffer_load_dword v15, v14, s[32:35], 0 offen sc1
K_nofl:
    ds_write_b128 v8, v[40:43]
    ds_write_b128 v8, v[40:43] offset:1024
    s_bitcmp1_b32 s2, 7
    s_cbranch_scc0 K_pub
    s_lshl_b32 s40, s18, 13
    s_add_u32 s40, s40, 40960
    v_add_u32 v9, s40, v1
    s_lshl_b32 s40, s22, 2
    s_and_b32 s41, s18, 2
    s_add_u32 s40, s40, s41
    s_lshl_b32 s12, s40, 16
    s_lshl_b32 s40, s21, 2
    s_and_b32 s41, s18, 1
    s_lshl_b32 s41, s41, 1
    s_add_u32 s40, s40, s41
    s_lshl_b32 s40, s40, 10
    s_add_u32 s12, s12, s40
    s_add_u32 s12, s12, 6291456
    s_add_u32 s13, s12, 65536
    s_mov_b32 s44, 1069066811
    s_mov_b32 s45, 1069066811
    s_mov_b32 s46, 897988541
    s_mov_b32 s47, 897988541
    s_barrier
    ds_read_b128 v[112:115], v9 offset:0
    ds_read_b128 v[116:119], v9 offset:1024
    ds_read_b128 v[120:123], v9 offset:2048
    ds_read_b128 v[124:127], v9 offset:3072
    ds_read_b128 v[128:131], v9 offset:4096
    ds_read_b128 v[132:135], v9 offset:5120
    ds_read_b128 v[136:139], v9 offset:6144
    ds_read_b128 v[140:143], v9 offset:7168
    s_mov_b32 s48, 0
    s_lshl_b32 s49, s60, 17
    s_lshl_b32 s50, s18, 10
    s_add_u32 s49, s49, s50
    s_add_u32 s49, s49, 2097152
    s_lshl_b32 s51, s60, 16
    s_lshl_b32 s40, s61, 10
    s_add_u32 s51, s51, s40
    s_cmp_lg_u32 s48, 0
    s_cbranch_scc1 K_er0
    s_waitcnt vmcnt(0)
    v_cmp_eq_u32 s[66:67], 0, v3
    v_cmp_ne_u32 vcc, v3, v15
    s_or_b64 vcc, vcc, s[66:67]
    s_mov_b32 s41, 0
    s_cbranch_scc0 K_early
    buffer_load_dword v3, v101, s[36:39], 0 offen sc1
    buffer_load_dword v15, v14, s[32:35], 0 offen sc1
K_er0:
    s_waitcnt lgkmcnt(4)
    v_pk_mul_f32 v[144:145], v[112:113], s[44:45]
    v_pk_mul_f32 v[146:147], v[114:115], s[44:45]
    v_pk_mul_f32 v[148:149], v[116:117], s[44:45]
    v_pk_mul_f32 v[150:151], v[118:119], s[44:45]
    v_pk_mul_f32 v[152:153], v[120:121], s[44:45]
    v_pk_mul_f32 v[154:155], v[122:123], s[44:45]
    v_pk_mul_f32 v[156:157], v[124:125], s[44:45]
    v_pk_mul_f32 v[158:159], v[126:127], s[44:45]
    v_exp_f32_e64 v144, v144 clamp
    v_exp_f32_e64 v145, v145 clamp
    v_exp_f32_e64 v146, v146 clamp
    v_exp_f32_e64 v147, v147 clamp
    v_exp_f32_e64 v148, v148 clamp
    v_exp_f32_e64 v149, v149 clamp
    v_exp_f32_e64 v150, v150 clamp
    v_exp_f32_e64 v151, v151 clamp
    v_exp_f32_e64 v152, v152 clamp
    v_exp_f32_e64 v153, v153 clamp
    v_exp_f32_e64 v154, v154 clamp
    v_exp_f32_e64 v155, v155 clamp
    v_exp_f32_e64 v156, v156 clamp
    v_exp_f32_e64 v157, v157 clamp
    v_exp_f32_e64 v158, v158 clamp
    v_exp_f32_e64 v159, v159 clamp
    v_max_f32 v112, 0, v112
    v_max_f32 v113, 0, v113
    v_max_f32 v114, 0, v114
    v_max_f32 v115, 0, v115
    v_max_f32 v116, 0, v116
    v_max_f32 v117, 0, v117
    v_max_f32 v118, 0, v118
    v_max_f32 v119, 0, v119
    v_max_f32 v120, 0, v120
    v_max_f32 v121, 0, v121
    v_max_f32 v122, 0, v122
    v_max_f32 v123, 0, v123
    v_max_f32 v124, 0, v124
    v_max_f32 v125, 0, v125
    v_max_f32 v126, 0, v126
    v_max_f32 v127, 0, v127
    v_pk_add_f32 v[144:145], v[144:145], s[46:47]
    v_pk_add_f32 v[146:147], v[146:147], s[46:47]
    v_pk_add_f32 v[148:149], v[148:149], s[46:47]
    v_pk_add_f32 v[150:151], v[150:151], s[46:47]
    v_pk_add_f32 v[152:153], v[152:153], s[46:47]
    v_pk_add_f32 v[154:155], v[154:155], s[46:47]
    v_pk_add_f32 v[156:157], v[156:157], s[46:47]
    v_pk_add_f32 v[158:159], v[158:159], s[46:47]
    v_pk_add_f32 v[112:113], v[112:113], v[144:145]
    v_pk_add_f32 v[114:115], v[114:115], v[146:147]
    v_pk_add_f32 v[116:117], v[116:117], v[148:149]
    v_pk_add_f32 v[118:119], v[118:119], v[150:151]
    v_pk_add_f32 v[120:121], v[120:121], v[152:153]
    v_pk_add_f32 v[122:123], v[122:123], v[154:155]
    v_pk_add_f32 v[124:125], v[124:125], v[156:157]
    v_pk_add_f32 v[126:127], v[126:127], v[158:159]
    v_cvt_pk_bf16_f32 v160, v112, v113
    v_cvt_pk_bf16_f32 v161, v114, v115
    v_cvt_pk_bf16_f32 v162, v116, v117
    v_cvt_pk_bf16_f32 v163, v118, v119
    v_cvt_pk_bf16_f32 v168, v120, v121
    v_cvt_pk_bf16_f32 v169, v122, v123
    v_cvt_pk_bf16_f32 v170, v124, v125
    v_cvt_pk_bf16_f32 v171, v126, v127
    s_cmp_lg_u32 s48, 0
    s_cbranch_scc1 K_er1
    s_waitcnt vmcnt(0)
    v_cmp_eq_u32 s[66:67], 0, v3
    v_cmp_ne_u32 vcc, v3, v15
    s_or_b64 vcc, vcc, s[66:67]
    s_mov_b32 s41, 1
    s_cbranch_scc0 K_early
    buffer_load_dword v3, v101, s[36:39], 0 offen sc1
    buffer_load_dword v15, v14, s[32:35], 0 offen sc1
K_er1:
    s_waitcnt lgkmcnt(0)
    v_pk_mul_f32 v[144:145], v[128:129], s[44:45]
    v_pk_mul_f32 v[146:147], v[130:131], s[44:45]
    v_pk_mul_f32 v[148:149], v[132:133], s[44:45]
    v_pk_mul_f32 v[150:151], v[134:135], s[44:45]
    v_pk_mul_f32 v[152:153], v[136:137], s[44:45]
    v_pk_mul_f32 v[154:155], v[138:139], s[44:45]
    v_pk_mul_f32 v[156:157], v[140:141], s[44:45]
    v_pk_mul_f32 v[158:159], v[142:143], s[44:45]
    v_exp_f32_e64 v144, v144 clamp
    v_exp_f32_e64 v145, v145 clamp
    v_exp_f32_e64 v146, v146 clamp
    v_exp_f32_e64 v147, v147 clamp
    v_exp_f32_e64 v148, v148 clamp
    v_exp_f32_e64 v149, v149 clamp
    v_exp_f32_e64 v150, v150 clamp
    v_exp_f32_e64 v151, v151 clamp
    v_exp_f32_e64 v152, v152 clamp
    v_exp_f32_e64 v153, v153 clamp
    v_exp_f32_e64 v154, v154 clamp
    v_exp_f32_e64 v155, v155 clamp
    v_exp_f32_e64 v156, v156 clamp
    v_exp_f32_e64 v157, v157 clamp
    v_exp_f32_e64 v158, v158 clamp
    v_exp_f32_e64 v159, v159 clamp
    v_max_f32 v128, 0, v128
    v_max_f32 v129, 0, v129
    v_max_f32 v130, 0, v130
    v_max_f32 v131, 0, v131
    v_max_f32 v132, 0, v132
    v_max_f32 v133, 0, v133
    v_max_f32 v134, 0, v134
    v_max_f32 v135, 0, v135
    v_max_f32 v136, 0, v136
    v_max_f32 v137, 0, v137
    v_max_f32 v138, 0, v138
    v_max_f32 v139, 0, v139
    v_max_f32 v140, 0, v140
    v_max_f32 v141, 0, v141
    v_max_f32 v142, 0, v142
    v_max_f32 v143, 0, v143
    v_pk_add_f32 v[144:145], v[144:145], s[46:47]
    v_pk_add_f32 v[146:147], v[146:147], s[46:47]
    v_pk_add_f32 v[148:149], v[148:149], s[46:47]
    v_pk_add_f32 v[150:151], v[150:151], s[46:47]
    v_pk_add_f32 v[152:153], v[152:153], s[46:47]
    v_pk_add_f32 v[154:155], v[154:155], s[46:47]
    v_pk_add_f32 v[156:157], v[156:157], s[46:47]
    v_pk_add_f32 v[158:159], v[158:159], s[46:47]
    v_pk_add_f32 v[128:129], v[128:129], v[144:145]
    v_pk_add_f32 v[130:131], v[130:131], v[146:147]
    v_pk_add_f32 v[132:133], v[132:133], v[148:149]
    v_pk_add_f32 v[134:135], v[134:135], v[150:151]
    v_pk_add_f32 v[136:137], v[136:137], v[152:153]
    v_pk_add_f32 v[138:139], v[138:139], v[154:155]
    v_pk_add_f32 v[140:141], v[140:141], v[156:157]
    v_pk_add_f32 v[142:143], v[142:143], v[158:159]
    v_cvt_pk_bf16_f32 v164, v128, v129
    v_cvt_pk_bf16_f32 v165, v130, v131
    v_cvt_pk_bf16_f32 v166, v132, v133
    v_cvt_pk_bf16_f32 v167, v134, v135
    v_cvt_pk_bf16_f32 v172, v136, v137
    v_cvt_pk_bf16_f32 v173, v138, v139
    v_cvt_pk_bf16_f32 v174, v140, v141
    v_cvt_pk_bf16_f32 v175, v142, v143
    s_cmp_lg_u32 s48, 0
    s_cbranch_scc1 K_er2
    s_mov_b32 s65, 65536
    s_mov_b32 s41, 2
K_e2l:
    s_waitcnt vmcnt(0)
    v_cmp_eq_u32 s[66:67], 0, v3
    v_cmp_ne_u32 vcc, v3, v15
    s_or_b64 vcc, vcc, s[66:67]
    s_cbranch_scc0 K_early
    s_sub_u32 s65, s65, 1
    s_cbranch_scc1 K_early
    buffer_load_dword v3, v101, s[36:39], 0 offen sc1
    buffer_load_dword v15, v14, s[32:35], 0 offen sc1
    s_branch K_e2l
K_er2:
    v_mov_b32 v176, v1
    s_branch K_pub
K_compute:
    s_load_dwordx4 s[56:59], s[0:1], 48
    s_load_dwordx2 s[16:17], s[0:1], 64
    s_and_b32 s40, s2, 7
    s_lshl_b32 s60, s40, 2
    s_add_u32 s60, s60, s42
    s_lshr_b32 s61, s2, 5
    s_lshl_b32 s61, s61, 3
    s_add_u32 s61, s61, s20
    s_lshl_b32 s64, s2, 3
    s_add_u32 s64, s64, s20
    s_lshl_b32 s64, s64, 7
    s_lshr_b32 s70, s60, 2
    s_and_b32 s40, s70, 3
    s_lshl_b32 s40, s40, 8
    s_lshr_b32 s70, s70, 2
    s_lshl_b32 s70, s70, 3
    s_add_u32 s70, s70, s40
    s_and_b32 s40, s60, 2
    s_add_u32 s70, s70, s40
    v_lshlrev_b32 v1, 4, v2
    v_mov_b32 v176, 0
    s_mov_b32 s12, 0
    s_mov_b32 s13, 0
    s_and_b32 s18, s20, 1
    s_lshr_b32 s19, s20, 1
    v_and_b32 v5, 31, v2
    v_lshrrev_b32 v9, 5, v2
    s_lshl_b32 s40, s18, 6
    v_add_u32 v5, s40, v5
    v_lshrrev_b32 v6, 1, v5
    v_and_b32 v6, 7, v6
    v_xor_b32 v6, v6, v9
    v_lshlrev_b32 v6, 4, v6
    v_lshl_add_u32 v152, v5, 7, v6
    v_add_u32 v152, 40960, v152
    v_xor_b32 v153, 32, v152
    v_xor_b32 v154, 64, v152
    v_xor_b32 v155, 96, v152
    v_bfe_u32 v5, v2, 2, 2
    v_lshl_add_u32 v6, v9, 3, v5
    v_lshlrev_b32 v6, 7, v6
    v_bfe_u32 v7, v2, 4, 1
    v_lshlrev_b32 v7, 1, v7
    v_bfe_u32 v8, v2, 1, 1
    v_or_b32 v7, v7, v8
    s_lshl_b32 s40, s19, 2
    v_or_b32 v7, s40, v7
    v_lshlrev_b32 v5, 1, v5
    v_and_b32 v5, 4, v5
    v_xor_b32 v7, v7, v5
    v_lshl_add_u32 v6, v7, 4, v6
    v_and_b32 v8, 1, v2
    v_lshl_add_u32 v6, v8, 3, v6
    v_add_u32 v156, 57344, v6
    s_lshl_b32 s40, s22, 2
    s_lshl_b32 s41, s19, 1
    s_add_u32 s40, s40, s41
    s_lshl_b32 s43, s21, 2
    s_lshl_b32 s41, s18, 1
    s_add_u32 s43, s43, s41
    s_lshl_b32 s52, s40, 16
    s_lshl_b32 s41, s43, 10
    s_add_u32 s52, s52, s41
    s_add_u32 s53, s52, 65536
    s_lshl_b32 s54, s52, 1
    s_add_u32 s54, s54, 2097152
    s_add_u32 s55, s54, 131072
    s_add_u32 s68, s54, 1024
    s_add_u32 s69, s52, 8388608
    v_and_b32 v5, 0x33, v2
    v_and_b32 v6, 4, v2
    v_lshl_or_b32 v5, v6, 1, v5
    v_and_b32 v6, 8, v2
    v_lshrrev_b32 v6, 1, v6
    v_or_b32 v5, v5, v6
    v_lshlrev_b32 v10, 4, v5
    v_bfe_u32 v5, v2, 4, 1
    v_lshlrev_b32 v5, 17, v5
    v_lshl_add_u32 v5, v9, 9, v5
    v_and_b32 v6, 15, v2
    v_lshl_add_u32 v11, v6, 4, v5
    s_mov_b32 s49, 0
    v_mov_b32 v13, 0
    v_mov_b32 v14, 0
    s_mov_b32 s62, 0xffff
    s_mov_b32 s63, 0xffff
    s_waitcnt lgkmcnt(0)
    s_mov_b32 s32, s16
    s_mov_b32 s33, s17
    s_mov_b32 s34, 0x1000000
    s_mov_b32 s35, 0x20000
    s_mov_b32 s36, s58
    s_mov_b32 s37, s59
    s_mov_b32 s38, 0x100
    s_mov_b32 s39, 0x20000
    s_cmp_lg_u32 s64, 0
    s_cbranch_scc1 K_noepoch
    s_mov_b64 exec, 1
    s_mov_b32 s66, 16515072
    buffer_load_dword v12, v13, s[32:35], s66 offen sc1
    s_mov_b32 s67, 0x9e3779b1
    s_waitcnt vmcnt(0)
    v_mul_lo_u32 v12, v12, s67
    v_add_u32 v12, 0x7f4a7c15, v12
    v_max_u32 v12, 1, v12
    buffer_store_dword v12, v13, s[36:39], 0 offen sc1
    buffer_store_dword v12, v13, s[32:35], s66 offen sc1
    s_mov_b64 exec, -1
K_noepoch:
    s_barrier
    ds_read_b128 v[112:115], v152 offset:0
    ds_read_b64_tr_b16 v[128:129], v156 offset:0
    ds_read_b64_tr_b16 v[130:131], v156 offset:512
    ds_read_b128 v[116:119], v152 offset:4096
    ds_read_b64_tr_b16 v[132:133], v156 offset:8192
    ds_read_b64_tr_b16 v[134:135], v156 offset:8704
    ds_read_b64_tr_b16 v[136:137], v156 offset:16384
    ds_read_b64_tr_b16 v[138:139], v156 offset:16896
    s_mov_b32 s48, 8
    s_bitcmp1_b32 s2, 7
    s_cbranch_scc1 K_gemm1
K_gemm0:
    s_waitcnt lgkmcnt(5)
    v_mfma_f32_32x32x16_bf16 v[16:31], v[128:131], v[112:115], 0
    ds_read_b128 v[120:123], v153 offset:0
    ds_read_b64_tr_b16 v[140:141], v156 offset:2048
    s_waitcnt lgkmcnt(6)
    v_mfma_f32_32x32x16_bf16 v[32:47], v[128:131], v[116:119], 0
    ds_read_b64_tr_b16 v[142:143], v156 offset:2560
    ds_read_b128 v[124:127], v153 offset:4096
    s_waitcnt lgkmcnt(6)
    v_mfma_f32_32x32x16_bf16 v[48:63], v[132:135], v[112:115], 0
    ds_read_b64_tr_b16 v[144:145], v156 offset:10240
    v_mfma_f32_32x32x16_bf16 v[64:79], v[132:135], v[116:119], 0
    ds_read_b64_tr_b16 v[146:147], v156 offset:10752
    s_waitcnt lgkmcnt(6)
    v_mfma_f32_32x32x16_bf16 v[80:95], v[112:115], v[136:139], 0
    ds_read_b64_tr_b16 v[148:149], v156 offset:18432
    v_mfma_f32_32x32x16_bf16 v[96:111], v[116:119], v[136:139], 0
    ds_read_b64_tr_b16 v[150:151], v156 offset:18944
    s_branch K_cin0
K_cloop0:
    s_waitcnt lgkmcnt(5)
    v_mfma_f32_32x32x16_bf16 v[16:31], v[128:131], v[112:115], v[16:31]
    ds_read_b128 v[120:123], v153 offset:0
    ds_read_b64_tr_b16 v[140:141], v156 offset:2048
    s_waitcnt lgkmcnt(6)
    v_mfma_f32_32x32x16_bf16 v[32:47], v[128:131], v[116:119], v[32:47]
    ds_read_b64_tr_b16 v[142:143], v156 offset:2560
    ds_read_b128 v[124:127], v153 offset:4096
    s_waitcnt lgkmcnt(6)
    v_mfma_f32_32x32x16_bf16 v[48:63], v[132:135], v[112:115], v[48:63]
    ds_read_b64_tr_b16 v[144:145], v156 offset:10240
    v_mfma_f32_32x32x16_bf16 v[64:79], v[132:135], v[116:119], v[64:79]
    ds_read_b64_tr_b16 v[146:147], v156 offset:10752
    s_waitcnt lgkmcnt(6)
    v_mfma_f32_32x32x16_bf16 v[80:95], v[112:115], v[136:139], v[80:95]
    ds_read_b64_tr_b16 v[148:149], v156 offset:18432
    v_mfma_f32_32x32x16_bf16 v[96:111], v[116:119], v[136:139], v[96:111]
    ds_read_b64_tr_b16 v[150:151], v156 offset:18944
    s_cmp_lg_u32 s48, 2
    s_cbranch_scc1 K_cin0
    buffer_load_dword v3, v13, s[36:39], 0 offen sc1
K_cin0:
    s_waitcnt lgkmcnt(5)
    v_mfma_f32_32x32x16_bf16 v[16:31], v[140:143], v[120:123], v[16:31]
    ds_read_b128 v[112:115], v154 offset:0
    ds_read_b64_tr_b16 v[128:129], v156 offset:4096
    s_waitcnt lgkmcnt(6)
    v_mfma_f32_32x32x16_bf16 v[32:47], v[140:143], v[124:127], v[32:47]
    ds_read_b64_tr_b16 v[130:131], v156 offset:4608
    ds_read_b128 v[116:119], v154 offset:4096
    s_waitcnt lgkmcnt(6)
    v_mfma_f32_32x32x16_bf16 v[48:63], v[144:147], v[120:123], v[48:63]
    ds_read_b64_tr_b16 v[132:133], v156 offset:12288
    v_mfma_f32_32x32x16_bf16 v[64:79], v[144:147], v[124:127], v[64:79]
    ds_read_b64_tr_b16 v[134:135], v156 offset:12800
    s_waitcnt lgkmcnt(6)
    v_mfma_f32_32x32x16_bf16 v[80:95], v[120:123], v[148:151], v[80:95]
    ds_read_b64_tr_b16 v[136:137], v156 offset:20480
    v_mfma_f32_32x32x16_bf16 v[96:111], v[124:127], v[148:151], v[96:111]
    ds_read_b64_tr_b16 v[138:139], v156 offset:20992
    s_add_u32 s50, s49, 40960
    s_cmp_eq_u32 s50, 122880
    s_cselect_b32 s50, 0, s50
    s_sub_u32 s51, s50, s49
    s_mov_b32 s49, s50
    s_waitcnt lgkmcnt(5)
    v_mfma_f32_32x32x16_bf16 v[16:31], v[128:131], v[112:115], v[16:31]
    ds_read_b128 v[120:123], v155 offset:0
    ds_read_b64_tr_b16 v[140:141], v156 offset:6144
    s_waitcnt lgkmcnt(6)
    v_mfma_f32_32x32x16_bf16 v[32:47], v[128:131], v[116:119], v[32:47]
    ds_read_b64_tr_b16 v[142:143], v156 offset:6656
    ds_read_b128 v[124:127], v155 offset:4096
    s_waitcnt lgkmcnt(6)
    v_mfma_f32_32x32x16_bf16 v[48:63], v[132:135], v[112:115], v[48:63]
    ds_read_b64_tr_b16 v[144:145], v156 offset:14336
    v_mfma_f32_32x32x16_bf16 v[64:79], v[132:135], v[116:119], v[64:79]
    ds_read_b64_tr_b16 v[146:147], v156 offset:14848
    s_waitcnt lgkmcnt(6)
    v_mfma_f32_32x32x16_bf16 v[80:95], v[112:115], v[136:139], v[80:95]
    ds_read_b64_tr_b16 v[148:149], v156 offset:22528
    v_mfma_f32_32x32x16_bf16 v[96:111], v[116:119], v[136:139], v[96:111]
    ds_read_b64_tr_b16 v[150:151], v156 offset:23040
    v_add_u32 v152, s51, v152
    v_add_u32 v153, s51, v153
    v_add_u32 v154, s51, v154
    v_add_u32 v155, s51, v155
    v_add_u32 v156, s51, v156
    s_waitcnt lgkmcnt(5)
    v_mfma_f32_32x32x16_bf16 v[16:31], v[140:143], v[120:123], v[16:31]
    s_waitcnt lgkmcnt(4)
    v_mfma_f32_32x32x16_bf16 v[32:47], v[140:143], v[124:127], v[32:47]
    s_sub_u32 s48, s48, 1
    s_cmp_eq_u32 s48, 1
    s_waitcnt lgkmcnt(0)
    s_barrier
    s_cbranch_scc1 K_cout0
    ds_read_b128 v[112:115], v152 offset:0
    ds_read_b64_tr_b16 v[128:129], v156 offset:0
    v_mfma_f32_32x32x16_bf16 v[48:63], v[144:147], v[120:123], v[48:63]
    ds_read_b64_tr_b16 v[130:131], v156 offset:512
    ds_read_b128 v[116:119], v152 offset:4096
    v_mfma_f32_32x32x16_bf16 v[64:79], v[144:147], v[124:127], v[64:79]
    ds_read_b64_tr_b16 v[132:133], v156 offset:8192
    ds_read_b64_tr_b16 v[134:135], v156 offset:8704
    v_mfma_f32_32x32x16_bf16 v[80:95], v[120:123], v[148:151], v[80:95]
    ds_read_b64_tr_b16 v[136:137], v156 offset:16384
    ds_read_b64_tr_b16 v[138:139], v156 offset:16896
    v_mfma_f32_32x32x16_bf16 v[96:111], v[124:127], v[148:151], v[96:111]
    s_branch K_cloop0
K_cout0:
    s_mov_b32 s44, 1052289595
    s_mov_b32 s45, 1052289595
    ds_read_b128 v[160:163], v152 offset:0
    ds_read_b64_tr_b16 v[196:197], v156 offset:8192
    ds_read_b64_tr_b16 v[198:199], v156 offset:8704
    v_mfma_f32_32x32x16_bf16 v[48:63], v[144:147], v[120:123], v[48:63]
    ds_read_b128 v[164:167], v152 offset:4096
    ds_read_b128 v[168:171], v153 offset:0
    ds_read_b64_tr_b16 v[208:209], v156 offset:10240
    v_mfma_f32_32x32x16_bf16 v[64:79], v[144:147], v[124:127], v[64:79]
    ds_read_b64_tr_b16 v[210:211], v156 offset:10752
    ds_read_b128 v[172:175], v153 offset:4096
    ds_read_b128 v[176:179], v154 offset:0
    v_mfma_f32_32x32x16_bf16 v[80:95], v[120:123], v[148:151], v[80:95]
    ds_read_b64_tr_b16 v[220:221], v156 offset:12288
    ds_read_b64_tr_b16 v[222:223], v156 offset:12800
    ds_read_b128 v[180:183], v154 offset:4096
    v_mfma_f32_32x32x16_bf16 v[96:111], v[124:127], v[148:151], v[96:111]
    s_waitcnt lgkmcnt(9)
    v_mfma_f32_32x32x16_bf16 v[48:63], v[196:199], v[160:163], v[48:63]
    ds_read_b128 v[184:187], v155 offset:0
    ds_read_b64_tr_b16 v[232:233], v156 offset:14336
    s_waitcnt lgkmcnt(10)
    v_mfma_f32_32x32x16_bf16 v[64:79], v[196:199], v[164:167], v[64:79]
    ds_read_b64_tr_b16 v[234:235], v156 offset:14848
    ds_read_b128 v[188:191], v155 offset:4096
    s_waitcnt lgkmcnt(9)
    v_mfma_f32_32x32x16_bf16 v[48:63], v[208:211], v[168:171], v[48:63]
    ds_read_b64_tr_b16 v[200:201], v156 offset:16384
    ds_read_b64_tr_b16 v[202:203], v156 offset:16896
    s_waitcnt lgkmcnt(10)
    v_mfma_f32_32x32x16_bf16 v[64:79], v[208:211], v[172:175], v[64:79]
    ds_read_b64_tr_b16 v[212:213], v156 offset:18432
    ds_read_b64_tr_b16 v[214:215], v156 offset:18944
    s_waitcnt lgkmcnt(9)
    v_mfma_f32_32x32x16_bf16 v[48:63], v[220:223], v[176:179], v[48:63]
    ds_read_b64_tr_b16 v[224:225], v156 offset:20480
    ds_read_b64_tr_b16 v[226:227], v156 offset:20992
    s_waitcnt lgkmcnt(10)
    v_mfma_f32_32x32x16_bf16 v[64:79], v[220:223], v[180:183], v[64:79]
    ds_read_b64_tr_b16 v[236:237], v156 offset:22528
    ds_read_b64_tr_b16 v[238:239], v156 offset:23040
    s_waitcnt lgkmcnt(9)
    v_mfma_f32_32x32x16_bf16 v[48:63], v[232:235], v[184:187], v[48:63]
    ds_read_b64_tr_b16 v[192:193], v156 offset:0
    ds_read_b64_tr_b16 v[194:195], v156 offset:512
    s_waitcnt lgkmcnt(10)
    v_mfma_f32_32x32x16_bf16 v[64:79], v[232:235], v[188:191], v[64:79]
    ds_read_b64_tr_b16 v[204:205], v156 offset:2048
    ds_read_b64_tr_b16 v[206:207], v156 offset:2560
    s_waitcnt lgkmcnt(10)
    v_mfma_f32_32x32x16_bf16 v[80:95], v[160:163], v[200:203], v[80:95]
    ds_read_b64_tr_b16 v[216:217], v156 offset:4096
    ds_read_b64_tr_b16 v[218:219], v156 offset:4608
    v_mfma_f32_32x32x16_bf16 v[96:111], v[164:167], v[200:203], v[96:111]
    ds_read_b64_tr_b16 v[228:229], v156 offset:6144
    ds_read_b64_tr_b16 v[230:231], v156 offset:6656
    s_nop 7
    v_cvt_pk_bf16_f32 v112, v48, v49
    v_cvt_pk_bf16_f32 v113, v50, v51
    v_cvt_pk_bf16_f32 v114, v52, v53
    v_cvt_pk_bf16_f32 v115, v54, v55
    s_waitcnt lgkmcnt(12)
    v_mfma_f32_32x32x16_bf16 v[80:95], v[168:171], v[212:215], v[80:95]
    buffer_store_dwordx4 v[112:115], v10, s[32:35], s54 offen offset:0 sc1
    v_cvt_pk_bf16_f32 v116, v56, v57
    v_cvt_pk_bf16_f32 v117, v58, v59
    v_cvt_pk_bf16_f32 v118, v60, v61
    v_mfma_f32_32x32x16_bf16 v[96:111], v[172:175], v[212:215], v[96:111]
    v_cvt_pk_bf16_f32 v119, v62, v63
    buffer_store_dwordx4 v[116:119], v10, s[32:35], s55 offen offset:0 sc1
    v_cvt_pk_bf16_f32 v120, v64, v65
    v_cvt_pk_bf16_f32 v121, v66, v67
    s_waitcnt lgkmcnt(10)
    v_mfma_f32_32x32x16_bf16 v[80:95], v[176:179], v[224:227], v[80:95]
    v_cvt_pk_bf16_f32 v122, v68, v69
    v_cvt_pk_bf16_f32 v123, v70, v71
    buffer_store_dwordx4 v[120:123], v10, s[32:35], s54 offen offset:2048 sc1
    v_cvt_pk_bf16_f32 v124, v72, v73
    v_mfma_f32_32x32x16_bf16 v[96:111], v[180:183], v[224:227], v[96:111]
    v_cvt_pk_bf16_f32 v125, v74, v75
    v_cvt_pk_bf16_f32 v126, v76, v77
    v_cvt_pk_bf16_f32 v127, v78, v79
    buffer_store_dwordx4 v[124:127], v10, s[32:35], s55 offen offset:2048 sc1
    s_waitcnt lgkmcnt(8)
    v_mfma_f32_32x32x16_bf16 v[80:95], v[184:187], v[236:239], v[80:95]
    v_mfma_f32_32x32x16_bf16 v[96:111], v[188:191], v[236:239], v[96:111]
    s_waitcnt lgkmcnt(6)
    v_mfma_f32_32x32x16_bf16 v[16:31], v[192:195], v[160:163], v[16:31]
    v_mfma_f32_32x32x16_bf16 v[32:47], v[192:195], v[164:167], v[32:47]
    s_nop 7
    v_cvt_pk_bf16_f32 v128, v80, v81
    v_cvt_pk_bf16_f32 v129, v82, v83
    v_cvt_pk_bf16_f32 v130, v84, v85
    v_cvt_pk_bf16_f32 v131, v86, v87
    s_waitcnt lgkmcnt(4)
    v_mfma_f32_32x32x16_bf16 v[16:31], v[204:207], v[168:171], v[16:31]
    buffer_store_dwordx4 v[128:131], v11, s[32:35], s68 offen offset:0 sc1
    v_cvt_pk_bf16_f32 v132, v88, v89
    v_cvt_pk_bf16_f32 v133, v90, v91
    v_cvt_pk_bf16_f32 v134, v92, v93
    v_mfma_f32_32x32x16_bf16 v[32:47], v[204:207], v[172:175], v[32:47]
    v_cvt_pk_bf16_f32 v135, v94, v95
    buffer_store_dwordx4 v[132:135], v11, s[32:35], s68 offen offset:256 sc1
    v_cvt_pk_bf16_f32 v136, v96, v97
    v_cvt_pk_bf16_f32 v137, v98, v99
    s_waitcnt lgkmcnt(2)
    v_mfma_f32_32x32x16_bf16 v[16:31], v[216:219], v[176:179], v[16:31]
    v_cvt_pk_bf16_f32 v138, v100, v101
    v_cvt_pk_bf16_f32 v139, v102, v103
    buffer_store_dwordx4 v[136:139], v11, s[32:35], s68 offen offset:2048 sc1
    v_cvt_pk_bf16_f32 v140, v104, v105
    v_mfma_f32_32x32x16_bf16 v[32:47], v[216:219], v[180:183], v[32:47]
    v_cvt_pk_bf16_f32 v141, v106, v107
    v_cvt_pk_bf16_f32 v142, v108, v109
    v_cvt_pk_bf16_f32 v143, v110, v111
    buffer_store_dwordx4 v[140:143], v11, s[32:35], s68 offen offset:2304 sc1
    s_waitcnt lgkmcnt(0)
    v_mfma_f32_32x32x16_bf16 v[16:31], v[228:231], v[184:187], v[16:31]
    v_mfma_f32_32x32x16_bf16 v[32:47], v[228:231], v[188:191], v[32:47]
    s_nop 7
    s_nop 2
    v_pk_mul_f32 v[16:17], v[16:17], s[44:45]
    v_pk_mul_f32 v[18:19], v[18:19], s[44:45]
    v_pk_mul_f32 v[20:21], v[20:21], s[44:45]
    v_pk_mul_f32 v[22:23], v[22:23], s[44:45]
    v_pk_mul_f32 v[24:25], v[24:25], s[44:45]
    v_pk_mul_f32 v[26:27], v[26:27], s[44:45]
    v_pk_mul_f32 v[28:29], v[28:29], s[44:45]
    v_pk_mul_f32 v[30:31], v[30:31], s[44:45]
    v_cvt_pk_bf16_f32 v48, v16, v17
    v_cvt_pk_bf16_f32 v49, v18, v19
    v_cvt_pk_bf16_f32 v50, v20, v21
    v_cvt_pk_bf16_f32 v51, v22, v23
    v_cvt_pk_bf16_f32 v52, v24, v25
    v_cvt_pk_bf16_f32 v53, v26, v27
    v_cvt_pk_bf16_f32 v54, v28, v29
    v_cvt_pk_bf16_f32 v55, v30, v31
    buffer_store_dwordx4 v[48:51], v1, s[32:35], s52 offen offset:0 sc1
    buffer_store_dwordx4 v[52:55], v1, s[32:35], s53 offen offset:0 sc1
    v_pk_mul_f32 v[32:33], v[32:33], s[44:45]
    v_pk_mul_f32 v[34:35], v[34:35], s[44:45]
    v_pk_mul_f32 v[36:37], v[36:37], s[44:45]
    v_pk_mul_f32 v[38:39], v[38:39], s[44:45]
    v_pk_mul_f32 v[40:41], v[40:41], s[44:45]
    v_pk_mul_f32 v[42:43], v[42:43], s[44:45]
    v_pk_mul_f32 v[44:45], v[44:45], s[44:45]
    v_pk_mul_f32 v[46:47], v[46:47], s[44:45]
    v_cvt_pk_bf16_f32 v64, v32, v33
    v_cvt_pk_bf16_f32 v65, v34, v35
    v_cvt_pk_bf16_f32 v66, v36, v37
    v_cvt_pk_bf16_f32 v67, v38, v39
    v_cvt_pk_bf16_f32 v68, v40, v41
    v_cvt_pk_bf16_f32 v69, v42, v43
    v_cvt_pk_bf16_f32 v70, v44, v45
    v_cvt_pk_bf16_f32 v71, v46, v47
    buffer_store_dwordx4 v[64:67], v1, s[32:35], s52 offen offset:1024 sc1
    buffer_store_dwordx4 v[68:71], v1, s[32:35], s53 offen offset:1024 sc1
    s_branch K_pub
K_gemm1:
    s_waitcnt lgkmcnt(5)
    v_mfma_f32_32x32x16_bf16 v[16:31], v[128:131], v[112:115], 0
    ds_read_b128 v[120:123], v153 offset:0
    ds_read_b64_tr_b16 v[140:141], v156 offset:2048
    s_waitcnt lgkmcnt(6)
    v_mfma_f32_32x32x16_bf16 v[32:47], v[128:131], v[116:119], 0
    ds_read_b64_tr_b16 v[142:143], v156 offset:2560
    ds_read_b128 v[124:127], v153 offset:4096
    s_waitcnt lgkmcnt(6)
    v_mfma_f32_32x32x16_bf16 v[48:63], v[112:115], v[132:135], 0
    ds_read_b64_tr_b16 v[144:145], v156 offset:10240
    v_mfma_f32_32x32x16_bf16 v[64:79], v[116:119], v[132:135], 0
    ds_read_b64_tr_b16 v[146:147], v156 offset:10752
    s_waitcnt lgkmcnt(6)
    v_mfma_f32_32x32x16_bf16 v[80:95], v[112:115], v[136:139], 0
    ds_read_b64_tr_b16 v[148:149], v156 offset:18432
    v_mfma_f32_32x32x16_bf16 v[96:111], v[116:119], v[136:139], 0
    ds_read_b64_tr_b16 v[150:151], v156 offset:18944
    s_branch K_cin1
K_cloop1:
    s_waitcnt lgkmcnt(5)
    v_mfma_f32_32x32x16_bf16 v[16:31], v[128:131], v[112:115], v[16:31]
    ds_read_b128 v[120:123], v153 offset:0
    ds_read_b64_tr_b16 v[140:141], v156 offset:2048
    s_waitcnt lgkmcnt(6)
    v_mfma_f32_32x32x16_bf16 v[32:47], v[128:131], v[116:119], v[32:47]
    ds_read_b64_tr_b16 v[142:143], v156 offset:2560
    ds_read_b128 v[124:127], v153 offset:4096
    s_waitcnt lgkmcnt(6)
    v_mfma_f32_32x32x16_bf16 v[48:63], v[112:115], v[132:135], v[48:63]
    ds_read_b64_tr_b16 v[144:145], v156 offset:10240
    v_mfma_f32_32x32x16_bf16 v[64:79], v[116:119], v[132:135], v[64:79]
    ds_read_b64_tr_b16 v[146:147], v156 offset:10752
    s_waitcnt lgkmcnt(6)
    v_mfma_f32_32x32x16_bf16 v[80:95], v[112:115], v[136:139], v[80:95]
    ds_read_b64_tr_b16 v[148:149], v156 offset:18432
    v_mfma_f32_32x32x16_bf16 v[96:111], v[116:119], v[136:139], v[96:111]
    ds_read_b64_tr_b16 v[150:151], v156 offset:18944
    s_cmp_lg_u32 s48, 2
    s_cbranch_scc1 K_cin1
    buffer_load_dword v3, v13, s[36:39], 0 offen sc1
K_cin1:
    s_waitcnt lgkmcnt(5)
    v_mfma_f32_32x32x16_bf16 v[16:31], v[140:143], v[120:123], v[16:31]
    ds_read_b128 v[112:115], v154 offset:0
    ds_read_b64_tr_b16 v[128:129], v156 offset:4096
    s_waitcnt lgkmcnt(6)
    v_mfma_f32_32x32x16_bf16 v[32:47], v[140:143], v[124:127], v[32:47]
    ds_read_b64_tr_b16 v[130:131], v156 offset:4608
    ds_read_b128 v[116:119], v154 offset:4096
    s_waitcnt lgkmcnt(6)
    v_mfma_f32_32x32x16_bf16 v[48:63], v[120:123], v[144:147], v[48:63]
    ds_read_b64_tr_b16 v[132:133], v156 offset:12288
    v_mfma_f32_32x32x16_bf16 v[64:79], v[124:127], v[144:147], v[64:79]
    ds_read_b64_tr_b16 v[134:135], v156 offset:12800
    s_waitcnt lgkmcnt(6)
    v_mfma_f32_32x32x16_bf16 v[80:95], v[120:123], v[148:151], v[80:95]
    ds_read_b64_tr_b16 v[136:137], v156 offset:20480
    v_mfma_f32_32x32x16_bf16 v[96:111], v[124:127], v[148:151], v[96:111]
    ds_read_b64_tr_b16 v[138:139], v156 offset:20992
    s_add_u32 s50, s49, 40960
    s_cmp_eq_u32 s50, 122880
    s_cselect_b32 s50, 0, s50
    s_sub_u32 s51, s50, s49
    s_mov_b32 s49, s50
    s_waitcnt lgkmcnt(5)
    v_mfma_f32_32x32x16_bf16 v[16:31], v[128:131], v[112:115], v[16:31]
    ds_read_b128 v[120:123], v155 offset:0
    ds_read_b64_tr_b16 v[140:141], v156 offset:6144
    s_waitcnt lgkmcnt(6)
    v_mfma_f32_32x32x16_bf16 v[32:47], v[128:131], v[116:119], v[32:47]
    ds_read_b64_tr_b16 v[142:143], v156 offset:6656
    ds_read_b128 v[124:127], v155 offset:4096
    s_waitcnt lgkmcnt(6)
    v_mfma_f32_32x32x16_bf16 v[48:63], v[112:115], v[132:135], v[48:63]
    ds_read_b64_tr_b16 v[144:145], v156 offset:14336
    v_mfma_f32_32x32x16_bf16 v[64:79], v[116:119], v[132:135], v[64:79]
    ds_read_b64_tr_b16 v[146:147], v156 offset:14848
    s_waitcnt lgkmcnt(6)
    v_mfma_f32_32x32x16_bf16 v[80:95], v[112:115], v[136:139], v[80:95]
    ds_read_b64_tr_b16 v[148:149], v156 offset:22528
    v_mfma_f32_32x32x16_bf16 v[96:111], v[116:119], v[136:139], v[96:111]
    ds_read_b64_tr_b16 v[150:151], v156 offset:23040
    v_add_u32 v152, s51, v152
    v_add_u32 v153, s51, v153
    v_add_u32 v154, s51, v154
    v_add_u32 v155, s51, v155
    v_add_u32 v156, s51, v156
    s_waitcnt lgkmcnt(5)
    v_mfma_f32_32x32x16_bf16 v[16:31], v[140:143], v[120:123], v[16:31]
    s_waitcnt lgkmcnt(4)
    v_mfma_f32_32x32x16_bf16 v[32:47], v[140:143], v[124:127], v[32:47]
    s_sub_u32 s48, s48, 1
    s_cmp_eq_u32 s48, 1
    s_waitcnt lgkmcnt(0)
    s_barrier
    s_cbranch_scc1 K_cout1
    ds_read_b128 v[112:115], v152 offset:0
    ds_read_b64_tr_b16 v[128:129], v156 offset:0
    v_mfma_f32_32x32x16_bf16 v[48:63], v[120:123], v[144:147], v[48:63]
    ds_read_b64_tr_b16 v[130:131], v156 offset:512
    ds_read_b128 v[116:119], v152 offset:4096
    v_mfma_f32_32x32x16_bf16 v[64:79], v[124:127], v[144:147], v[64:79]
    ds_read_b64_tr_b16 v[132:133], v156 offset:8192
    ds_read_b64_tr_b16 v[134:135], v156 offset:8704
    v_mfma_f32_32x32x16_bf16 v[80:95], v[120:123], v[148:151], v[80:95]
    ds_read_b64_tr_b16 v[136:137], v156 offset:16384
    ds_read_b64_tr_b16 v[138:139], v156 offset:16896
    v_mfma_f32_32x32x16_bf16 v[96:111], v[124:127], v[148:151], v[96:111]
    s_branch K_cloop1
K_cout1:
    s_lshl_b32 s40, s20, 13
    s_add_u32 s40, s40, 40960
    v_add_u32 v9, s40, v1
    s_mov_b32 s44, 1069066811
    s_mov_b32 s45, 1069066811
    s_mov_b32 s46, 897988541
    s_mov_b32 s47, 897988541
    ds_read_b128 v[160:163], v152 offset:0
    ds_read_b64_tr_b16 v[192:193], v156 offset:0
    ds_read_b64_tr_b16 v[194:195], v156 offset:512
    v_mfma_f32_32x32x16_bf16 v[48:63], v[120:123], v[144:147], v[48:63]
    ds_read_b128 v[164:167], v152 offset:4096
    ds_read_b128 v[168:171], v153 offset:0
    ds_read_b64_tr_b16 v[204:205], v156 offset:2048
    v_mfma_f32_32x32x16_bf16 v[64:79], v[124:127], v[144:147], v[64:79]
    ds_read_b64_tr_b16 v[206:207], v156 offset:2560
    ds_read_b128 v[172:175], v153 offset:4096
    ds_read_b128 v[176:179], v154 offset:0
    v_mfma_f32_32x32x16_bf16 v[80:95], v[120:123], v[148:151], v[80:95]
    ds_read_b64_tr_b16 v[216:217], v156 offset:4096
    ds_read_b64_tr_b16 v[218:219], v156 offset:4608
    ds_read_b128 v[180:183], v154 offset:4096
    v_mfma_f32_32x32x16_bf16 v[96:111], v[124:127], v[148:151], v[96:111]
    s_waitcnt lgkmcnt(9)
    v_mfma_f32_32x32x16_bf16 v[16:31], v[192:195], v[160:163], v[16:31]
    ds_read_b128 v[184:187], v155 offset:0
    ds_read_b64_tr_b16 v[228:229], v156 offset:6144
    s_waitcnt lgkmcnt(10)
    v_mfma_f32_32x32x16_bf16 v[32:47], v[192:195], v[164:167], v[32:47]
    ds_read_b64_tr_b16 v[230:231], v156 offset:6656
    ds_read_b128 v[188:191], v155 offset:4096
    s_waitcnt lgkmcnt(9)
    v_mfma_f32_32x32x16_bf16 v[16:31], v[204:207], v[168:171], v[16:31]
    ds_read_b64_tr_b16 v[196:197], v156 offset:8192
    ds_read_b64_tr_b16 v[198:199], v156 offset:8704
    s_waitcnt lgkmcnt(10)
    v_mfma_f32_32x32x16_bf16 v[32:47], v[204:207], v[172:175], v[32:47]
    ds_read_b64_tr_b16 v[208:209], v156 offset:10240
    ds_read_b64_tr_b16 v[210:211], v156 offset:10752
    s_waitcnt lgkmcnt(9)
    v_mfma_f32_32x32x16_bf16 v[16:31], v[216:219], v[176:179], v[16:31]
    ds_read_b64_tr_b16 v[220:221], v156 offset:12288
    ds_read_b64_tr_b16 v[222:223], v156 offset:12800
    s_waitcnt lgkmcnt(10)
    v_mfma_f32_32x32x16_bf16 v[32:47], v[216:219], v[180:183], v[32:47]
    ds_read_b64_tr_b16 v[232:233], v156 offset:14336
    ds_read_b64_tr_b16 v[234:235], v156 offset:14848
    s_waitcnt lgkmcnt(9)
    v_mfma_f32_32x32x16_bf16 v[16:31], v[228:231], v[184:187], v[16:31]
    ds_read_b64_tr_b16 v[200:201], v156 offset:16384
    ds_read_b64_tr_b16 v[202:203], v156 offset:16896
    s_waitcnt lgkmcnt(10)
    v_mfma_f32_32x32x16_bf16 v[32:47], v[228:231], v[188:191], v[32:47]
    ds_read_b64_tr_b16 v[212:213], v156 offset:18432
    ds_read_b64_tr_b16 v[214:215], v156 offset:18944
    s_waitcnt lgkmcnt(10)
    v_mfma_f32_32x32x16_bf16 v[48:63], v[160:163], v[196:199], v[48:63]
    ds_read_b64_tr_b16 v[224:225], v156 offset:20480
    ds_read_b64_tr_b16 v[226:227], v156 offset:20992
    v_mfma_f32_32x32x16_bf16 v[64:79], v[164:167], v[196:199], v[64:79]
    ds_read_b64_tr_b16 v[236:237], v156 offset:22528
    ds_read_b64_tr_b16 v[238:239], v156 offset:23040
    s_waitcnt lgkmcnt(12)
    v_mfma_f32_32x32x16_bf16 v[48:63], v[168:171], v[208:211], v[48:63]
    s_nop 1
    ds_write_b128 v9, v[16:19] offset:0
    ds_write_b128 v9, v[20:23] offset:1024
    s_waitcnt lgkmcnt(8)
    ds_write_b128 v9, v[24:27] offset:2048
    v_mfma_f32_32x32x16_bf16 v[64:79], v[172:175], v[208:211], v[64:79]
    ds_write_b128 v9, v[28:31] offset:3072
    ds_write_b128 v9, v[32:35] offset:4096
    ds_write_b128 v9, v[36:39] offset:5120
    v_mfma_f32_32x32x16_bf16 v[48:63], v[176:179], v[220:223], v[48:63]
    ds_write_b128 v9, v[40:43] offset:6144
    ds_write_b128 v9, v[44:47] offset:7168
    v_mfma_f32_32x32x16_bf16 v[64:79], v[180:183], v[220:223], v[64:79]
    v_mfma_f32_32x32x16_bf16 v[48:63], v[184:187], v[232:235], v[48:63]
    s_waitcnt lgkmcnt(0)
    s_barrier
    v_mfma_f32_32x32x16_bf16 v[64:79], v[188:191], v[232:235], v[64:79]
    v_mfma_f32_32x32x16_bf16 v[80:95], v[160:163], v[200:203], v[80:95]
    v_mfma_f32_32x32x16_bf16 v[96:111], v[164:167], v[200:203], v[96:111]
    s_nop 7
    v_pk_mul_f32 v[112:113], v[48:49], s[44:45]
    v_pk_mul_f32 v[114:115], v[50:51], s[44:45]
    v_pk_mul_f32 v[116:117], v[52:53], s[44:45]
    v_pk_mul_f32 v[118:119], v[54:55], s[44:45]
    v_pk_mul_f32 v[120:121], v[56:57], s[44:45]
    v_pk_mul_f32 v[122:123], v[58:59], s[44:45]
    v_mfma_f32_32x32x16_bf16 v[80:95], v[168:171], v[212:215], v[80:95]
    v_pk_mul_f32 v[124:125], v[60:61], s[44:45]
    v_pk_mul_f32 v[126:127], v[62:63], s[44:45]
    v_exp_f32_e64 v112, v112 clamp
    v_exp_f32_e64 v113, v113 clamp
    v_mfma_f32_32x32x16_bf16 v[96:111], v[172:175], v[212:215], v[96:111]
    v_exp_f32_e64 v114, v114 clamp
    v_exp_f32_e64 v115, v115 clamp
    v_exp_f32_e64 v116, v116 clamp
    v_mfma_f32_32x32x16_bf16 v[80:95], v[176:179], v[224:227], v[80:95]
    v_exp_f32_e64 v117, v117 clamp
    v_exp_f32_e64 v118, v118 clamp
    v_exp_f32_e64 v119, v119 clamp
    v_mfma_f32_32x32x16_bf16 v[96:111], v[180:183], v[224:227], v[96:111]
    v_exp_f32_e64 v120, v120 clamp
    v_exp_f32_e64 v121, v121 clamp
    v_exp_f32_e64 v122, v122 clamp
    v_mfma_f32_32x32x16_bf16 v[80:95], v[184:187], v[236:239], v[80:95]
    v_exp_f32_e64 v123, v123 clamp
    v_exp_f32_e64 v124, v124 clamp
    v_exp_f32_e64 v125, v125 clamp
    v_mfma_f32_32x32x16_bf16 v[96:111], v[188:191], v[236:239], v[96:111]
    v_exp_f32_e64 v126, v126 clamp
    v_exp_f32_e64 v127, v127 clamp
    v_max_f32 v48, 0, v48
    v_max_f32 v49, 0, v49
    v_max_f32 v50, 0, v50
    v_max_f32 v51, 0, v51
    v_max_f32 v52, 0, v52
    v_max_f32 v53, 0, v53
    v_max_f32 v54, 0, v54
    v_max_f32 v55, 0, v55
    v_max_f32 v56, 0, v56
    v_max_f32 v57, 0, v57
    v_max_f32 v58, 0, v58
    v_max_f32 v59, 0, v59
    v_max_f32 v60, 0, v60
    v_max_f32 v61, 0, v61
    v_max_f32 v62, 0, v62
    v_max_f32 v63, 0, v63
    v_pk_add_f32 v[112:113], v[112:113], s[46:47]
    v_pk_add_f32 v[114:115], v[114:115], s[46:47]
    v_pk_add_f32 v[116:117], v[116:117], s[46:47]
    v_pk_add_f32 v[118:119], v[118:119], s[46:47]
    v_pk_add_f32 v[120:121], v[120:121], s[46:47]
    v_pk_add_f32 v[122:123], v[122:123], s[46:47]
    v_pk_add_f32 v[124:125], v[124:125], s[46:47]
    v_pk_add_f32 v[126:127], v[126:127], s[46:47]
    v_pk_add_f32 v[48:49], v[48:49], v[112:113]
    v_pk_add_f32 v[50:51], v[50:51], v[114:115]
    v_pk_add_f32 v[52:53], v[52:53], v[116:117]
    v_pk_add_f32 v[54:55], v[54:55], v[118:119]
    v_pk_add_f32 v[56:57], v[56:57], v[120:121]
    v_pk_add_f32 v[58:59], v[58:59], v[122:123]
    v_pk_add_f32 v[60:61], v[60:61], v[124:125]
    v_pk_add_f32 v[62:63], v[62:63], v[126:127]
    v_cvt_pk_bf16_f32 v128, v48, v49
    v_cvt_pk_bf16_f32 v129, v50, v51
    v_cvt_pk_bf16_f32 v130, v52, v53
    v_cvt_pk_bf16_f32 v131, v54, v55
    v_cvt_pk_bf16_f32 v132, v56, v57
    v_cvt_pk_bf16_f32 v133, v58, v59
    v_cvt_pk_bf16_f32 v134, v60, v61
    v_cvt_pk_bf16_f32 v135, v62, v63
    v_pk_mul_f32 v[112:113], v[64:65], s[44:45]
    v_pk_mul_f32 v[114:115], v[66:67], s[44:45]
    v_pk_mul_f32 v[116:117], v[68:69], s[44:45]
    v_pk_mul_f32 v[118:119], v[70:71], s[44:45]
    v_pk_mul_f32 v[120:121], v[72:73], s[44:45]
    v_pk_mul_f32 v[122:123], v[74:75], s[44:45]
    v_pk_mul_f32 v[124:125], v[76:77], s[44:45]
    v_pk_mul_f32 v[126:127], v[78:79], s[44:45]
    v_exp_f32_e64 v112, v112 clamp
    v_exp_f32_e64 v113, v113 clamp
    v_exp_f32_e64 v114, v114 clamp
    v_exp_f32_e64 v115, v115 clamp
    v_exp_f32_e64 v116, v116 clamp
    v_exp_f32_e64 v117, v117 clamp
    v_exp_f32_e64 v118, v118 clamp
    v_exp_f32_e64 v119, v119 clamp
    v_exp_f32_e64 v120, v120 clamp
    v_exp_f32_e64 v121, v121 clamp
    v_exp_f32_e64 v122, v122 clamp
    v_exp_f32_e64 v123, v123 clamp
    v_exp_f32_e64 v124, v124 clamp
    v_exp_f32_e64 v125, v125 clamp
    v_exp_f32_e64 v126, v126 clamp
    v_exp_f32_e64 v127, v127 clamp
    v_max_f32 v64, 0, v64
    v_max_f32 v65, 0, v65
    v_max_f32 v66, 0, v66
    v_max_f32 v67, 0, v67
    v_max_f32 v68, 0, v68
    v_max_f32 v69, 0, v69
    v_max_f32 v70, 0, v70
    v_max_f32 v71, 0, v71
    v_max_f32 v72, 0, v72
    v_max_f32 v73, 0, v73
    v_max_f32 v74, 0, v74
    v_max_f32 v75, 0, v75
    v_max_f32 v76, 0, v76
    v_max_f32 v77, 0, v77
    v_max_f32 v78, 0, v78
    v_max_f32 v79, 0, v79
    v_pk_add_f32 v[112:113], v[112:113], s[46:47]
    v_pk_add_f32 v[114:115], v[114:115], s[46:47]
    v_pk_add_f32 v[116:117], v[116:117], s[46:47]
    v_pk_add_f32 v[118:119], v[118:119], s[46:47]
    v_pk_add_f32 v[120:121], v[120:121], s[46:47]
    v_pk_add_f32 v[122:123], v[122:123], s[46:47]
    v_pk_add_f32 v[124:125], v[124:125], s[46:47]
    v_pk_add_f32 v[126:127], v[126:127], s[46:47]
    v_pk_add_f32 v[64:65], v[64:65], v[112:113]
    v_pk_add_f32 v[66:67], v[66:67], v[114:115]
    v_pk_add_f32 v[68:69], v[68:69], v[116:117]
    v_pk_add_f32 v[70:71], v[70:71], v[118:119]
    v_pk_add_f32 v[72:73], v[72:73], v[120:121]
    v_pk_add_f32 v[74:75], v[74:75], v[122:123]
    v_pk_add_f32 v[76:77], v[76:77], v[124:125]
    v_pk_add_f32 v[78:79], v[78:79], v[126:127]
    v_cvt_pk_bf16_f32 v136, v64, v65
    v_cvt_pk_bf16_f32 v137, v66, v67
    v_cvt_pk_bf16_f32 v138, v68, v69
    v_cvt_pk_bf16_f32 v139, v70, v71
    v_cvt_pk_bf16_f32 v140, v72, v73
    v_cvt_pk_bf16_f32 v141, v74, v75
    v_cvt_pk_bf16_f32 v142, v76, v77
    v_cvt_pk_bf16_f32 v143, v78, v79
    v_mov_b32 v144, 1065369472
    v_mov_b32 v145, v144
    v_mov_b32 v146, v144
    v_mov_b32 v147, v144
    v_xor_b32 v176, 256, v1
    v_cvt_pk_bf16_f32 v180, v80, v81
    v_cvt_pk_bf16_f32 v181, v82, v83
    v_cvt_pk_bf16_f32 v182, v84, v85
    v_cvt_pk_bf16_f32 v183, v86, v87
    v_cvt_pk_bf16_f32 v184, v88, v89
    v_cvt_pk_bf16_f32 v185, v90, v91
    v_cvt_pk_bf16_f32 v186, v92, v93
    v_cvt_pk_bf16_f32 v187, v94, v95
    v_cvt_pk_bf16_f32 v188, v96, v97
    v_cvt_pk_bf16_f32 v189, v98, v99
    v_cvt_pk_bf16_f32 v190, v100, v101
    v_cvt_pk_bf16_f32 v191, v102, v103
    v_cvt_pk_bf16_f32 v192, v104, v105
    v_cvt_pk_bf16_f32 v193, v106, v107
    v_cvt_pk_bf16_f32 v194, v108, v109
    v_cvt_pk_bf16_f32 v195, v110, v111
    s_nop 1
    v_mfma_f32_32x32x16_bf16 v[48:63], v[128:131], v[180:183], 0
    v_mfma_f32_32x32x16_bf16 v[64:79], v[128:131], v[144:147], 0
    v_mfma_f32_32x32x16_bf16 v[48:63], v[132:135], v[184:187], v[48:63]
    v_mfma_f32_32x32x16_bf16 v[64:79], v[132:135], v[144:147], v[64:79]
    v_mfma_f32_32x32x16_bf16 v[48:63], v[136:139], v[188:191], v[48:63]
    v_mfma_f32_32x32x16_bf16 v[64:79], v[136:139], v[144:147], v[64:79]
    v_mfma_f32_32x32x16_bf16 v[48:63], v[140:143], v[192:195], v[48:63]
    v_mfma_f32_32x32x16_bf16 v[64:79], v[140:143], v[144:147], v[64:79]
    s_nop 7
    s_nop 3
    v_cndmask_b32 v160, v64, v48, s[62:63]
    v_cndmask_b32 v161, v65, v49, s[62:63]
    v_cndmask_b32 v162, v66, v50, s[62:63]
    v_cndmask_b32 v163, v67, v51, s[62:63]
    v_cndmask_b32 v164, v68, v52, s[62:63]
    v_cndmask_b32 v165, v69, v53, s[62:63]
    v_cndmask_b32 v166, v70, v54, s[62:63]
    v_cndmask_b32 v167, v71, v55, s[62:63]
    v_cndmask_b32 v168, v56, v72, s[62:63]
    v_cndmask_b32 v169, v57, v73, s[62:63]
    v_cndmask_b32 v170, v58, v74, s[62:63]
    v_cndmask_b32 v171, v59, v75, s[62:63]
    v_cndmask_b32 v172, v60, v76, s[62:63]
    v_cndmask_b32 v173, v61, v77, s[62:63]
    v_cndmask_b32 v174, v62, v78, s[62:63]
    v_cndmask_b32 v175, v63, v79, s[62:63]
    s_mov_b32 s12, s69
    s_add_u32 s13, s69, 65536
K_pub:
    v_mov_b32 v85, v1
    s_mov_b32 s62, 0xffff
    s_mov_b32 s63, 0xffff
    v_and_b32 v6, 11, v2
    v_cmp_ne_u32 vcc, 0, v6
    v_mov_b32 v6, 134144
    v_mov_b32 v7, 134160
    v_cndmask_b32 v6, v6, v7, vcc
    v_cndmask_b32 v86, v6, v1, s[62:63]
    v_mov_b32 v6, 8192
    v_cndmask_b32 v87, 0, v6, s[62:63]
    v_mov_b32 v84, 0xdddddddd
    v_mov_b32 v91, 0
    s_lshl_b32 s41, s20, 10
    s_lshl_b32 s43, s60, 17
    s_add_u32 s43, s43, s41
    s_add_u32 s43, s43, 2097152
    s_lshl_b32 s44, s60, 16
    s_lshl_b32 s40, s61, 10
    s_add_u32 s44, s44, s40
    s_mov_b32 m0, s41
    v_mov_b32 v68, 0
    v_mov_b32 v69, 0
    v_mov_b32 v70, 0
    v_mov_b32 v71, 0
    v_mov_b32 v72, 0
    v_mov_b32 v73, 0
    v_mov_b32 v74, 0
    v_mov_b32 v75, 0
    v_mov_b32 v76, 0
    v_mov_b32 v77, 0
    v_mov_b32 v78, 0
    v_mov_b32 v79, 0
    v_mov_b32 v80, 0
    v_mov_b32 v81, 0
    v_mov_b32 v82, 0
    v_mov_b32 v83, 0
    s_and_b32 s45, s2, 7
    s_lshl_b32 s45, s45, 3
    s_bfe_u32 s40, s2, 0x30003
    s_add_u32 s45, s45, s40
    s_lshr_b32 s46, s2, 6
    s_and_b32 s18, s20, 3
    s_lshr_b32 s19, s20, 2
    s_lshl_b32 s47, s46, 2
    s_add_u32 s47, s47, s18
    s_lshl_b32 s48, s47, 15
    s_xor_b32 s40, s19, 1
    s_lshl_b32 s40, s40, 19
    s_add_u32 s48, s48, s40
    s_add_u32 s48, s48, 14680064
    s_lshl_b32 s40, s60, 16
    s_lshl_b32 s49, s61, 10
    s_add_u32 s49, s49, s40
    s_add_u32 s49, s49, 6291456
    s_lshl_b32 s50, s20, 13
    s_add_u32 s50, s50, s40
    s_add_u32 s50, s50, 8388608
    s_lshl_b32 s51, s61, 15
    s_lshl_b32 s40, s60, 10
    s_add_u32 s51, s51, s40
    s_add_u32 s51, s51, 10485760
    s_add_u32 s55, s51, 2097152
    s_lshl_b32 s52, s45, 15
    s_lshl_b32 s40, s20, 12
    s_add_u32 s53, s52, s40
    s_add_u32 s53, s53, 12582912
    s_lshl_b32 s40, s18, 13
    s_add_u32 s52, s52, s40
    s_add_u32 s52, s52, 10485760
    s_and_b32 s69, s2, 128
    s_lshr_b32 s40, s69, 5
    s_or_b32 s40, s40, s20
    s_cmp_lt_u32 s40, 4
    s_cbranch_scc1 K_w4
    s_waitcnt vmcnt(0)
K_w4:
    s_waitcnt vmcnt(4)
    v_cmp_eq_u32 vcc, 0, v3
    s_cbranch_vccnz R_tag
C_tag:
    s_cmp_lg_u32 s69, 0
    s_cbranch_scc1 K_pubB
    s_add_u32 s66, s64, 15728640
    s_mov_b64 exec, 1
    v_mov_b32 v4, 0
    buffer_store_dword v3, v4, s[32:35], s66 offen sc1
    s_mov_b64 exec, -1
    s_waitcnt vmcnt(1)
    s_add_u32 s66, s64, 15990784
    s_mov_b64 exec, 1
    v_mov_b32 v4, 0
    buffer_store_dword v3, v4, s[32:35], s66 offen sc1
    s_mov_b64 exec, -1
    s_barrier
    s_cmp_lg_u32 s20, 4
    s_cbranch_scc1 C_f1
    buffer_load_dword v15, v14, s[32:35], 0 offen sc1
    s_waitcnt vmcnt(0)
    v_cmp_ne_u32 vcc, v3, v15
    s_cbranch_vccnz R_f1
C_f1:
    s_barrier
    buffer_load_dwordx4 v[8:11], v1, s[32:35], s44 offen sc1
    buffer_load_dwordx4 v1, s[32:35], s43 offen sc1 lds
    s_add_u32 m0, m0, 8192
    s_add_u32 s43, s43, 8192
    buffer_load_dwordx4 v1, s[32:35], s43 offen sc1 lds
    s_waitcnt vmcnt(0) lgkmcnt(0)
    s_barrier
K_x0d:
    ds_read_b128 v[12:15], v85
    ds_read_b128 v[16:19], v85 offset:2048
    ds_read_b128 v[20:23], v86 offset:1024
    ds_read_b128 v[24:27], v86 offset:1280
    s_waitcnt lgkmcnt(3)
    v_mfma_f32_32x32x16_bf16 v[36:51], v[12:15], v[8:11], 0
    s_nop 7
    s_nop 3
    v_exp_f32 v36, v36
    v_exp_f32 v37, v37
    s_waitcnt lgkmcnt(2)
    s_setprio 3
    s_add_u32 m0, m0, 8192
    s_add_u32 s43, s43, 8192
    ds_read_b128 v[12:15], v85 offset:4096
    buffer_load_dwordx4 v1, s[32:35], s43 offen sc1 lds
    v_exp_f32 v38, v38
    v_exp_f32 v39, v39
    v_exp_f32 v40, v40
    v_exp_f32 v41, v41
    v_mfma_f32_32x32x16_bf16 v[52:67], v[16:19], v[8:11], 0
    s_waitcnt lgkmcnt(1)
    ds_read_b128 v[28:31], v86 offset:3072
    v_exp_f32 v42, v42
    v_exp_f32 v43, v43
    v_exp_f32 v44, v44
    v_exp_f32 v45, v45
    v_exp_f32 v46, v46
    v_smfmac_f32_32x32x32_bf16 v[68:83], v[20:23], v[36:43], v84
    s_add_u32 m0, m0, 8192
    s_add_u32 s43, s43, 8192
    ds_read_b128 v[32:35], v86 offset:3328
    buffer_load_dwordx4 v1, s[32:35], s43 offen sc1 lds
    v_exp_f32 v47, v47
    v_exp_f32 v48, v48
    v_exp_f32 v49, v49
    v_exp_f32 v50, v50
    v_exp_f32 v51, v51
    v_exp_f32 v52, v52
    v_exp_f32 v53, v53
    v_smfmac_f32_32x32x32_bf16 v[68:83], v[24:27], v[44:51], v84
    s_waitcnt lgkmcnt(2)
    s_add_u32 m0, m0, 8192
    s_add_u32 s43, s43, 8192
    ds_read_b128 v[16:19], v85 offset:6144
    buffer_load_dwordx4 v1, s[32:35], s43 offen sc1 lds
    v_exp_f32 v54, v54
    v_exp_f32 v55, v55
    v_exp_f32 v56, v56
    v_exp_f32 v57, v57
    v_mfma_f32_32x32x16_bf16 v[36:51], v[12:15], v[8:11], 0
    s_waitcnt lgkmcnt(1)
    ds_read_b128 v[20:23], v86 offset:5120
    v_exp_f32 v58, v58
    v_exp_f32 v59, v59
    v_exp_f32 v60, v60
    v_exp_f32 v61, v61
    v_exp_f32 v62, v62
    v_smfmac_f32_32x32x32_bf16 v[68:83], v[28:31], v[52:59], v84
    s_add_u32 m0, m0, 8192
    s_add_u32 s43, s43, 8192
    ds_read_b128 v[24:27], v86 offset:5376
    buffer_load_dwordx4 v1, s[32:35], s43 offen sc1 lds
    v_exp_f32 v63, v63
    v_exp_f32 v64, v64
    v_exp_f32 v65, v65
    v_exp_f32 v66, v66
    v_exp_f32 v67, v67
    v_exp_f32 v36, v36
    v_exp_f32 v37, v37
    v_smfmac_f32_32x32x32_bf16 v[68:83], v[32:35], v[60:67], v84
    s_waitcnt lgkmcnt(2)
    s_add_u32 m0, m0, 8192
    s_add_u32 s43, s43, 8192
    ds_read_b128 v[12:15], v85 offset:8192
    buffer_load_dwordx4 v1, s[32:35], s43 offen sc1 lds
    v_exp_f32 v38, v38
    v_exp_f32 v39, v39
    v_exp_f32 v40, v40
    v_exp_f32 v41, v41
    v_mfma_f32_32x32x16_bf16 v[52:67], v[16:19], v[8:11], 0
    s_waitcnt lgkmcnt(1)
    ds_read_b128 v[28:31], v86 offset:7168
    v_exp_f32 v42, v42
    v_exp_f32 v43, v43
    v_exp_f32 v44, v44
    v_exp_f32 v45, v45
    v_exp_f32 v46, v46
    v_smfmac_f32_32x32x32_bf16 v[68:83], v[20:23], v[36:43], v84
    ds_read_b128 v[32:35], v86 offset:7424
    v_exp_f32 v47, v47
    v_exp_f32 v48, v48
    v_exp_f32 v49, v49
    v_exp_f32 v50, v50
    v_exp_f32 v51, v51
    v_exp_f32 v52, v52
    v_exp_f32 v53, v53
    v_smfmac_f32_32x32x32_bf16 v[68:83], v[24:27], v[44:51], v84
    s_waitcnt lgkmcnt(2)
    s_add_u32 m0, m0, 8192
    s_add_u32 s43, s43, 8192
    ds_read_b128 v[16:19], v85 offset:10240
    buffer_load_dwordx4 v1, s[32:35], s43 offen sc1 lds
    v_exp_f32 v54, v54
    v_exp_f32 v55, v55
    v_exp_f32 v56, v56
    v_exp_f32 v57, v57
    v_mfma_f32_32x32x16_bf16 v[36:51], v[12:15], v[8:11], 0
    s_waitcnt lgkmcnt(1)
    v_add_u32 v86, v87, v86
    ds_read_b128 v[20:23], v86 offset:1024
    v_exp_f32 v58, v58
    v_exp_f32 v59, v59
    v_exp_f32 v60, v60
    v_exp_f32 v61, v61
    v_exp_f32 v62, v62
    v_smfmac_f32_32x32x32_bf16 v[68:83], v[28:31], v[52:59], v84
    s_add_u32 m0, m0, 8192
    s_add_u32 s43, s43, 8192
    ds_read_b128 v[24:27], v86 offset:1280
    buffer_load_dwordx4 v1, s[32:35], s43 offen sc1 lds
    v_exp_f32 v63, v63
    v_exp_f32 v64, v64
    v_exp_f32 v65, v65
    v_exp_f32 v66, v66
    v_exp_f32 v67, v67
    v_exp_f32 v36, v36
    v_exp_f32 v37, v37
    v_smfmac_f32_32x32x32_bf16 v[68:83], v[32:35], v[60:67], v84
    s_waitcnt lgkmcnt(2)
    s_add_u32 m0, m0, 8192
    s_add_u32 s43, s43, 8192
    ds_read_b128 v[12:15], v85 offset:12288
    buffer_load_dwordx4 v1, s[32:35], s43 offen sc1 lds
    v_exp_f32 v38, v38
    v_exp_f32 v39, v39
    v_exp_f32 v40, v40
    v_exp_f32 v41, v41
    v_mfma_f32_32x32x16_bf16 v[52:67], v[16:19], v[8:11], 0
    s_waitcnt lgkmcnt(1)
    ds_read_b128 v[28:31], v86 offset:3072
    v_exp_f32 v42, v42
    v_exp_f32 v43, v43
    v_exp_f32 v44, v44
    v_exp_f32 v45, v45
    v_exp_f32 v46, v46
    v_smfmac_f32_32x32x32_bf16 v[68:83], v[20:23], v[36:43], v84
    ds_read_b128 v[32:35], v86 offset:3328
    v_exp_f32 v47, v47
    v_exp_f32 v48, v48
    v_exp_f32 v49, v49
    v_exp_f32 v50, v50
    v_exp_f32 v51, v51
    v_exp_f32 v52, v52
    v_exp_f32 v53, v53
    v_smfmac_f32_32x32x32_bf16 v[68:83], v[24:27], v[44:51], v84
    s_waitcnt lgkmcnt(2)
    s_add_u32 m0, m0, 8192
    s_add_u32 s43, s43, 8192
    ds_read_b128 v[16:19], v85 offset:14336
    buffer_load_dwordx4 v1, s[32:35], s43 offen sc1 lds
    v_exp_f32 v54, v54
    v_exp_f32 v55, v55
    v_exp_f32 v56, v56
    v_exp_f32 v57, v57
    v_mfma_f32_32x32x16_bf16 v[36:51], v[12:15], v[8:11], 0
    s_waitcnt lgkmcnt(1)
    ds_read_b128 v[20:23], v86 offset:5120
    v_exp_f32 v58, v58
    v_exp_f32 v59, v59
    v_exp_f32 v60, v60
    v_exp_f32 v61, v61
    v_exp_f32 v62, v62
    v_smfmac_f32_32x32x32_bf16 v[68:83], v[28:31], v[52:59], v84
    s_add_u32 m0, m0, 8192
    s_add_u32 s43, s43, 8192
    ds_read_b128 v[24:27], v86 offset:5376
    buffer_load_dwordx4 v1, s[32:35], s43 offen sc1 lds
    v_exp_f32 v63, v63
    v_exp_f32 v64, v64
    v_exp_f32 v65, v65
    v_exp_f32 v66, v66
    v_exp_f32 v67, v67
    s_waitcnt vmcnt(7)
    s_barrier
    v_exp_f32 v36, v36
    v_exp_f32 v37, v37
    v_smfmac_f32_32x32x32_bf16 v[68:83], v[32:35], v[60:67], v84
    s_waitcnt lgkmcnt(2)
    s_add_u32 m0, m0, 8192
    s_add_u32 s43, s43, 8192
    ds_read_b128 v[12:15], v85 offset:16384
    buffer_load_dwordx4 v1, s[32:35], s43 offen sc1 lds
    v_exp_f32 v38, v38
    v_exp_f32 v39, v39
    v_exp_f32 v40, v40
    v_exp_f32 v41, v41
    v_mfma_f32_32x32x16_bf16 v[52:67], v[16:19], v[8:11], 0
    s_waitcnt lgkmcnt(1)
    ds_read_b128 v[28:31], v86 offset:7168
    v_exp_f32 v42, v42
    v_exp_f32 v43, v43
    v_exp_f32 v44, v44
    v_exp_f32 v45, v45
    v_exp_f32 v46, v46
    v_smfmac_f32_32x32x32_bf16 v[68:83], v[20:23], v[36:43], v84
    ds_read_b128 v[32:35], v86 offset:7424
    v_exp_f32 v47, v47
    v_exp_f32 v48, v48
    v_exp_f32 v49, v49
    v_exp_f32 v50, v50
    v_exp_f32 v51, v51
    v_exp_f32 v52, v52
    v_exp_f32 v53, v53
    v_smfmac_f32_32x32x32_bf16 v[68:83], v[24:27], v[44:51], v84
    s_waitcnt lgkmcnt(2)
    s_add_u32 m0, m0, 8192
    s_add_u32 s43, s43, 8192
    ds_read_b128 v[16:19], v85 offset:18432
    buffer_load_dwordx4 v1, s[32:35], s43 offen sc1 lds
    v_exp_f32 v54, v54
    v_exp_f32 v55, v55
    v_exp_f32 v56, v56
    v_exp_f32 v57, v57
    v_mfma_f32_32x32x16_bf16 v[36:51], v[12:15], v[8:11], 0
    s_waitcnt lgkmcnt(1)
    v_add_u32 v86, v87, v86
    ds_read_b128 v[20:23], v86 offset:1024
    v_exp_f32 v58, v58
    v_exp_f32 v59, v59
    v_exp_f32 v60, v60
    v_exp_f32 v61, v61
    v_exp_f32 v62, v62
    v_smfmac_f32_32x32x32_bf16 v[68:83], v[28:31], v[52:59], v84
    s_add_u32 m0, m0, 8192
    s_add_u32 s43, s43, 8192
    ds_read_b128 v[24:27], v86 offset:1280
    buffer_load_dwordx4 v1, s[32:35], s43 offen sc1 lds
    v_exp_f32 v63, v63
    v_exp_f32 v64, v64
    v_exp_f32 v65, v65
    v_exp_f32 v66, v66
    v_exp_f32 v67, v67
    v_exp_f32 v36, v36
    v_exp_f32 v37, v37
    v_smfmac_f32_32x32x32_bf16 v[68:83], v[32:35], v[60:67], v84
    s_waitcnt lgkmcnt(2)
    s_add_u32 m0, m0, 8192
    s_add_u32 s43, s43, 8192
    ds_read_b128 v[12:15], v85 offset:20480
    buffer_load_dwordx4 v1, s[32:35], s43 offen sc1 lds
    v_exp_f32 v38, v38
    v_exp_f32 v39, v39
    v_exp_f32 v40, v40
    v_exp_f32 v41, v41
    v_mfma_f32_32x32x16_bf16 v[52:67], v[16:19], v[8:11], 0
    s_waitcnt lgkmcnt(1)
    ds_read_b128 v[28:31], v86 offset:3072
    v_exp_f32 v42, v42
    v_exp_f32 v43, v43
    v_exp_f32 v44, v44
    v_exp_f32 v45, v45
    v_exp_f32 v46, v46
    v_smfmac_f32_32x32x32_bf16 v[68:83], v[20:23], v[36:43], v84
    ds_read_b128 v[32:35], v86 offset:3328
    v_exp_f32 v47, v47
    v_exp_f32 v48, v48
    v_exp_f32 v49, v49
    v_exp_f32 v50, v50
    v_exp_f32 v51, v51
    s_cmp_eq_u32 s69, 0
    s_cbranch_scc1 K_nost
    buffer_store_dwordx4 v[160:163], v1, s[32:35], s12 offen sc1
    buffer_store_dwordx4 v[164:167], v1, s[32:35], s12 offen offset:1024 sc1
    buffer_store_dwordx4 v[168:171], v176, s[32:35], s13 offen sc1
    buffer_store_dwordx4 v[172:175], v176, s[32:35], s13 offen offset:1024 sc1
K_nost:
    v_exp_f32 v52, v52
    v_exp_f32 v53, v53
    v_smfmac_f32_32x32x32_bf16 v[68:83], v[24:27], v[44:51], v84
    s_waitcnt lgkmcnt(2)
    s_setprio 2
    ds_read_b128 v[16:19], v85 offset:22528
    v_exp_f32 v54, v54
    v_exp_f32 v55, v55
    v_exp_f32 v56, v56
    v_exp_f32 v57, v57
    v_mfma_f32_32x32x16_bf16 v[36:51], v[12:15], v[8:11], 0
    s_waitcnt lgkmcnt(1)
    ds_read_b128 v[20:23], v86 offset:5120
    v_exp_f32 v58, v58
    v_exp_f32 v59, v59
    v_exp_f32 v60, v60
    v_exp_f32 v61, v61
    v_exp_f32 v62, v62
    v_smfmac_f32_32x32x32_bf16 v[68:83], v[28:31], v[52:59], v84
    ds_read_b128 v[24:27], v86 offset:5376
    v_exp_f32 v63, v63
    v_exp_f32 v64, v64
    v_exp_f32 v65, v65
    v_exp_f32 v66, v66
    v_exp_f32 v67, v67
    v_exp_f32 v36, v36
    v_exp_f32 v37, v37
    v_smfmac_f32_32x32x32_bf16 v[68:83], v[32:35], v[60:67], v84
    s_waitcnt lgkmcnt(2)
    ds_read_b128 v[12:15], v85 offset:24576
    v_exp_f32 v38, v38
    v_exp_f32 v39, v39
    v_exp_f32 v40, v40
    v_exp_f32 v41, v41
    v_mfma_f32_32x32x16_bf16 v[52:67], v[16:19], v[8:11], 0
    s_waitcnt lgkmcnt(1)
    ds_read_b128 v[28:31], v86 offset:7168
    v_exp_f32 v42, v42
    v_exp_f32 v43, v43
    v_exp_f32 v44, v44
    v_exp_f32 v45, v45
    v_exp_f32 v46, v46
    v_smfmac_f32_32x32x32_bf16 v[68:83], v[20:23], v[36:43], v84
    ds_read_b128 v[32:35], v86 offset:7424
    v_exp_f32 v47, v47
    v_exp_f32 v48, v48
    v_exp_f32 v49, v49
    v_exp_f32 v50, v50
    v_exp_f32 v51, v51
    v_exp_f32 v52, v52
    v_exp_f32 v53, v53
    v_smfmac_f32_32x32x32_bf16 v[68:83], v[24:27], v[44:51], v84
    s_waitcnt lgkmcnt(2)
    ds_read_b128 v[16:19], v85 offset:26624
    v_exp_f32 v54, v54
    v_exp_f32 v55, v55
    v_exp_f32 v56, v56
    v_exp_f32 v57, v57
    v_mfma_f32_32x32x16_bf16 v[36:51], v[12:15], v[8:11], 0
    s_waitcnt lgkmcnt(1)
    v_add_u32 v86, v87, v86
    ds_read_b128 v[20:23], v86 offset:1024
    v_exp_f32 v58, v58
    v_exp_f32 v59, v59
    v_exp_f32 v60, v60
    v_exp_f32 v61, v61
    v_exp_f32 v62, v62
    v_smfmac_f32_32x32x32_bf16 v[68:83], v[28:31], v[52:59], v84
    ds_read_b128 v[24:27], v86 offset:1280
    v_exp_f32 v63, v63
    v_exp_f32 v64, v64
    v_exp_f32 v65, v65
    v_exp_f32 v66, v66
    v_exp_f32 v67, v67
    v_exp_f32 v36, v36
    v_exp_f32 v37, v37
    v_smfmac_f32_32x32x32_bf16 v[68:83], v[32:35], v[60:67], v84
    s_waitcnt lgkmcnt(2)
    ds_read_b128 v[12:15], v85 offset:28672
    v_exp_f32 v38, v38
    v_exp_f32 v39, v39
    v_exp_f32 v40, v40
    v_exp_f32 v41, v41
    v_mfma_f32_32x32x16_bf16 v[52:67], v[16:19], v[8:11], 0
    s_waitcnt lgkmcnt(1)
    ds_read_b128 v[28:31], v86 offset:3072
    v_exp_f32 v42, v42
    v_exp_f32 v43, v43
    v_exp_f32 v44, v44
    v_exp_f32 v45, v45
    v_exp_f32 v46, v46
    v_smfmac_f32_32x32x32_bf16 v[68:83], v[20:23], v[36:43], v84
    ds_read_b128 v[32:35], v86 offset:3328
    v_exp_f32 v47, v47
    v_exp_f32 v48, v48
    v_exp_f32 v49, v49
    v_exp_f32 v50, v50
    v_exp_f32 v51, v51
    v_exp_f32 v52, v52
    v_exp_f32 v53, v53
    v_smfmac_f32_32x32x32_bf16 v[68:83], v[24:27], v[44:51], v84
    s_waitcnt lgkmcnt(2)
    ds_read_b128 v[16:19], v85 offset:30720
    v_exp_f32 v54, v54
    v_exp_f32 v55, v55
    v_exp_f32 v56, v56
    v_exp_f32 v57, v57
    v_mfma_f32_32x32x16_bf16 v[36:51], v[12:15], v[8:11], 0
    s_waitcnt lgkmcnt(1)
    ds_read_b128 v[20:23], v86 offset:5120
    v_exp_f32 v58, v58
    v_exp_f32 v59, v59
    v_exp_f32 v60, v60
    v_exp_f32 v61, v61
    v_exp_f32 v62, v62
    v_smfmac_f32_32x32x32_bf16 v[68:83], v[28:31], v[52:59], v84
    ds_read_b128 v[24:27], v86 offset:5376
    v_exp_f32 v63, v63
    v_exp_f32 v64, v64
    v_exp_f32 v65, v65
    v_exp_f32 v66, v66
    v_exp_f32 v67, v67
    v_exp_f32 v36, v36
    v_exp_f32 v37, v37
    v_smfmac_f32_32x32x32_bf16 v[68:83], v[32:35], v[60:67], v84
    s_waitcnt lgkmcnt(2)
    s_setprio 1
    ds_read_b128 v[12:15], v85 offset:32768
    v_exp_f32 v38, v38
    v_exp_f32 v39, v39
    v_exp_f32 v40, v40
    v_exp_f32 v41, v41
    v_mfma_f32_32x32x16_bf16 v[52:67], v[16:19], v[8:11], 0
    s_waitcnt lgkmcnt(1)
    ds_read_b128 v[28:31], v86 offset:7168
    v_exp_f32 v42, v42
    v_exp_f32 v43, v43
    v_exp_f32 v44, v44
    v_exp_f32 v45, v45
    v_exp_f32 v46, v46
    v_smfmac_f32_32x32x32_bf16 v[68:83], v[20:23], v[36:43], v84
    ds_read_b128 v[32:35], v86 offset:7424
    v_exp_f32 v47, v47
    v_exp_f32 v48, v48
    v_exp_f32 v49, v49
    v_exp_f32 v50, v50
    v_exp_f32 v51, v51
    s_cmp_eq_u32 s69, 0
    s_cbranch_scc1 K_nolf
    s_waitcnt vmcnt(0)
    s_add_u32 s66, s64, 15728640
    s_mov_b64 exec, 1
    v_mov_b32 v4, 0
    buffer_store_dword v3, v4, s[32:35], s66 offen sc1
    s_mov_b64 exec, -1
K_nolf:
    v_exp_f32 v52, v52
    v_exp_f32 v53, v53
    v_smfmac_f32_32x32x32_bf16 v[68:83], v[24:27], v[44:51], v84
    s_waitcnt lgkmcnt(2)
    ds_read_b128 v[16:19], v85 offset:34816
    v_exp_f32 v54, v54
    v_exp_f32 v55, v55
    v_exp_f32 v56, v56
    v_exp_f32 v57, v57
    v_mfma_f32_32x32x16_bf16 v[36:51], v[12:15], v[8:11], 0
    s_waitcnt lgkmcnt(1)
    v_add_u32 v86, v87, v86
    ds_read_b128 v[20:23], v86 offset:1024
    v_exp_f32 v58, v58
    v_exp_f32 v59, v59
    v_exp_f32 v60, v60
    v_exp_f32 v61, v61
    v_exp_f32 v62, v62
    v_smfmac_f32_32x32x32_bf16 v[68:83], v[28:31], v[52:59], v84
    ds_read_b128 v[24:27], v86 offset:1280
    v_exp_f32 v63, v63
    v_exp_f32 v64, v64
    v_exp_f32 v65, v65
    v_exp_f32 v66, v66
    v_exp_f32 v67, v67
    v_exp_f32 v36, v36
    v_exp_f32 v37, v37
    v_smfmac_f32_32x32x32_bf16 v[68:83], v[32:35], v[60:67], v84
    s_waitcnt lgkmcnt(2)
    s_setprio 0
    ds_read_b128 v[12:15], v85 offset:36864
    v_exp_f32 v38, v38
    v_exp_f32 v39, v39
    v_exp_f32 v40, v40
    v_exp_f32 v41, v41
    v_mfma_f32_32x32x16_bf16 v[52:67], v[16:19], v[8:11], 0
    s_waitcnt lgkmcnt(1)
    ds_read_b128 v[28:31], v86 offset:3072
    v_exp_f32 v42, v42
    v_exp_f32 v43, v43
    v_exp_f32 v44, v44
    v_exp_f32 v45, v45
    v_exp_f32 v46, v46
    v_smfmac_f32_32x32x32_bf16 v[68:83], v[20:23], v[36:43], v84
    ds_read_b128 v[32:35], v86 offset:3328
    v_exp_f32 v47, v47
    v_exp_f32 v48, v48
    v_exp_f32 v49, v49
    v_exp_f32 v50, v50
    v_exp_f32 v51, v51
    v_exp_f32 v52, v52
    v_exp_f32 v53, v53
    v_smfmac_f32_32x32x32_bf16 v[68:83], v[24:27], v[44:51], v84
    s_waitcnt lgkmcnt(2)
    ds_read_b128 v[16:19], v85 offset:38912
    v_exp_f32 v54, v54
    v_exp_f32 v55, v55
    v_exp_f32 v56, v56
    v_exp_f32 v57, v57
    v_mfma_f32_32x32x16_bf16 v[36:51], v[12:15], v[8:11], 0
    s_waitcnt lgkmcnt(1)
    ds_read_b128 v[20:23], v86 offset:5120
    v_exp_f32 v58, v58
    v_exp_f32 v59, v59
    v_exp_f32 v60, v60
    v_exp_f32 v61, v61
    v_exp_f32 v62, v62
    v_smfmac_f32_32x32x32_bf16 v[68:83], v[28:31], v[52:59], v84
    ds_read_b128 v[24:27], v86 offset:5376
    v_exp_f32 v63, v63
    v_exp_f32 v64, v64
    v_exp_f32 v65, v65
    v_exp_f32 v66, v66
    v_exp_f32 v67, v67
    s_waitcnt vmcnt(0)
    s_barrier
    v_exp_f32 v36, v36
    v_exp_f32 v37, v37
    v_smfmac_f32_32x32x32_bf16 v[68:83], v[32:35], v[60:67], v84
    s_waitcnt lgkmcnt(2)
    s_setprio 3
    ds_read_b128 v[12:15], v85 offset:40960
    v_exp_f32 v38, v38
    v_exp_f32 v39, v39
    v_exp_f32 v40, v40
    v_exp_f32 v41, v41
    v_mfma_f32_32x32x16_bf16 v[52:67], v[16:19], v[8:11], 0
    s_waitcnt lgkmcnt(1)
    ds_read_b128 v[28:31], v86 offset:7168
    v_exp_f32 v42, v42
    v_exp_f32 v43, v43
    v_exp_f32 v44, v44
    v_exp_f32 v45, v45
    v_exp_f32 v46, v46
    v_smfmac_f32_32x32x32_bf16 v[68:83], v[20:23], v[36:43], v84
    ds_read_b128 v[32:35], v86 offset:7424
    v_exp_f32 v47, v47
    v_exp_f32 v48, v48
    v_exp_f32 v49, v49
    v_exp_f32 v50, v50
    v_exp_f32 v51, v51
    v_exp_f32 v52, v52
    v_exp_f32 v53, v53
    v_smfmac_f32_32x32x32_bf16 v[68:83], v[24:27], v[44:51], v84
    s_waitcnt lgkmcnt(2)
    ds_read_b128 v[16:19], v85 offset:43008
    v_exp_f32 v54, v54
    v_exp_f32 v55, v55
    v_exp_f32 v56, v56
    v_exp_f32 v57, v57
    v_mfma_f32_32x32x16_bf16 v[36:51], v[12:15], v[8:11], 0
    s_waitcnt lgkmcnt(1)
    v_add_u32 v86, v87, v86
    ds_read_b128 v[20:23], v86 offset:1024
    v_exp_f32 v58, v58
    v_exp_f32 v59, v59
    v_exp_f32 v60, v60
    v_exp_f32 v61, v61
    v_exp_f32 v62, v62
    v_smfmac_f32_32x32x32_bf16 v[68:83], v[28:31], v[52:59], v84
    ds_read_b128 v[24:27], v86 offset:1280
    v_exp_f32 v63, v63
    v_exp_f32 v64, v64
    v_exp_f32 v65, v65
    v_exp_f32 v66, v66
    v_exp_f32 v67, v67
    v_exp_f32 v36, v36
    v_exp_f32 v37, v37
    v_smfmac_f32_32x32x32_bf16 v[68:83], v[32:35], v[60:67], v84
    s_waitcnt lgkmcnt(2)
    ds_read_b128 v[12:15], v85 offset:45056
    v_exp_f32 v38, v38
    v_exp_f32 v39, v39
    v_exp_f32 v40, v40
    v_exp_f32 v41, v41
    v_mfma_f32_32x32x16_bf16 v[52:67], v[16:19], v[8:11], 0
    s_waitcnt lgkmcnt(1)
    ds_read_b128 v[28:31], v86 offset:3072
    v_exp_f32 v42, v42
    v_exp_f32 v43, v43
    v_exp_f32 v44, v44
    v_exp_f32 v45, v45
    v_exp_f32 v46, v46
    v_smfmac_f32_32x32x32_bf16 v[68:83], v[20:23], v[36:43], v84
    ds_read_b128 v[32:35], v86 offset:3328
    v_exp_f32 v47, v47
    v_exp_f32 v48, v48
    v_exp_f32 v49, v49
    v_exp_f32 v50, v50
    v_exp_f32 v51, v51
    v_exp_f32 v52, v52
    v_exp_f32 v53, v53
    v_smfmac_f32_32x32x32_bf16 v[68:83], v[24:27], v[44:51], v84
    s_waitcnt lgkmcnt(2)
    ds_read_b128 v[16:19], v85 offset:47104
    v_exp_f32 v54, v54
    v_exp_f32 v55, v55
    v_exp_f32 v56, v56
    v_exp_f32 v57, v57
    v_mfma_f32_32x32x16_bf16 v[36:51], v[12:15], v[8:11], 0
    s_waitcnt lgkmcnt(1)
    ds_read_b128 v[20:23], v86 offset:5120
    v_exp_f32 v58, v58
    v_exp_f32 v59, v59
    v_exp_f32 v60, v60
    v_exp_f32 v61, v61
    v_exp_f32 v62, v62
    v_smfmac_f32_32x32x32_bf16 v[68:83], v[28:31], v[52:59], v84
    ds_read_b128 v[24:27], v86 offset:5376
    v_exp_f32 v63, v63
    v_exp_f32 v64, v64
    v_exp_f32 v65, v65
    v_exp_f32 v66, v66
    v_exp_f32 v67, v67
    v_exp_f32 v36, v36
    v_exp_f32 v37, v37
    v_smfmac_f32_32x32x32_bf16 v[68:83], v[32:35], v[60:67], v84
    s_waitcnt lgkmcnt(2)
    ds_read_b128 v[12:15], v85 offset:49152
    v_exp_f32 v38, v38
    v_exp_f32 v39, v39
    v_exp_f32 v40, v40
    v_exp_f32 v41, v41
    v_mfma_f32_32x32x16_bf16 v[52:67], v[16:19], v[8:11], 0
    s_waitcnt lgkmcnt(1)
    ds_read_b128 v[28:31], v86 offset:7168
    v_exp_f32 v42, v42
    v_exp_f32 v43, v43
    v_exp_f32 v44, v44
    v_exp_f32 v45, v45
    v_exp_f32 v46, v46
    v_smfmac_f32_32x32x32_bf16 v[68:83], v[20:23], v[36:43], v84
    ds_read_b128 v[32:35], v86 offset:7424
    v_exp_f32 v47, v47
    v_exp_f32 v48, v48
    v_exp_f32 v49, v49
    v_exp_f32 v50, v50
    v_exp_f32 v51, v51
    v_exp_f32 v52, v52
    v_exp_f32 v53, v53
    v_smfmac_f32_32x32x32_bf16 v[68:83], v[24:27], v[44:51], v84
    s_waitcnt lgkmcnt(2)
    ds_read_b128 v[16:19], v85 offset:51200
    v_exp_f32 v54, v54
    v_exp_f32 v55, v55
    v_exp_f32 v56, v56
    v_exp_f32 v57, v57
    v_mfma_f32_32x32x16_bf16 v[36:51], v[12:15], v[8:11], 0
    s_waitcnt lgkmcnt(1)
    v_add_u32 v86, v87, v86
    ds_read_b128 v[20:23], v86 offset:1024
    v_exp_f32 v58, v58
    v_exp_f32 v59, v59
    v_exp_f32 v60, v60
    v_exp_f32 v61, v61
    v_exp_f32 v62, v62
    v_smfmac_f32_32x32x32_bf16 v[68:83], v[28:31], v[52:59], v84
    ds_read_b128 v[24:27], v86 offset:1280
    v_exp_f32 v63, v63
    v_exp_f32 v64, v64
    v_exp_f32 v65, v65
    v_exp_f32 v66, v66
    v_exp_f32 v67, v67
    v_exp_f32 v36, v36
    v_exp_f32 v37, v37
    v_smfmac_f32_32x32x32_bf16 v[68:83], v[32:35], v[60:67], v84
    s_waitcnt lgkmcnt(2)
    ds_read_b128 v[12:15], v85 offset:53248
    v_exp_f32 v38, v38
    v_exp_f32 v39, v39
    v_exp_f32 v40, v40
    v_exp_f32 v41, v41
    v_mfma_f32_32x32x16_bf16 v[52:67], v[16:19], v[8:11], 0
    s_waitcnt lgkmcnt(1)
    ds_read_b128 v[28:31], v86 offset:3072
    v_exp_f32 v42, v42
    v_exp_f32 v43, v43
    v_exp_f32 v44, v44
    v_exp_f32 v45, v45
    v_exp_f32 v46, v46
    v_smfmac_f32_32x32x32_bf16 v[68:83], v[20:23], v[36:43], v84
    ds_read_b128 v[32:35], v86 offset:3328
    v_exp_f32 v47, v47
    v_exp_f32 v48, v48
    v_exp_f32 v49, v49
    v_exp_f32 v50, v50
    v_exp_f32 v51, v51
    v_exp_f32 v52, v52
    v_exp_f32 v53, v53
    v_smfmac_f32_32x32x32_bf16 v[68:83], v[24:27], v[44:51], v84
    s_waitcnt lgkmcnt(2)
    ds_read_b128 v[16:19], v85 offset:55296
    v_exp_f32 v54, v54
    v_exp_f32 v55, v55
    v_exp_f32 v56, v56
    v_exp_f32 v57, v57
    v_mfma_f32_32x32x16_bf16 v[36:51], v[12:15], v[8:11], 0
    s_waitcnt lgkmcnt(1)
    ds_read_b128 v[20:23], v86 offset:5120
    v_exp_f32 v58, v58
    v_exp_f32 v59, v59
    v_exp_f32 v60, v60
    v_exp_f32 v61, v61
    v_exp_f32 v62, v62
    v_smfmac_f32_32x32x32_bf16 v[68:83], v[28:31], v[52:59], v84
    ds_read_b128 v[24:27], v86 offset:5376
    v_exp_f32 v63, v63
    v_exp_f32 v64, v64
    v_exp_f32 v65, v65
    v_exp_f32 v66, v66
    v_exp_f32 v67, v67
    v_exp_f32 v36, v36
    v_exp_f32 v37, v37
    v_smfmac_f32_32x32x32_bf16 v[68:83], v[32:35], v[60:67], v84
    s_waitcnt lgkmcnt(2)
    ds_read_b128 v[12:15], v85 offset:57344
    v_exp_f32 v38, v38
    v_exp_f32 v39, v39
    v_exp_f32 v40, v40
    v_exp_f32 v41, v41
    v_mfma_f32_32x32x16_bf16 v[52:67], v[16:19], v[8:11], 0
    s_waitcnt lgkmcnt(1)
    ds_read_b128 v[28:31], v86 offset:7168
    v_exp_f32 v42, v42
    v_exp_f32 v43, v43
    v_exp_f32 v44, v44
    v_exp_f32 v45, v45
    v_exp_f32 v46, v46
    v_smfmac_f32_32x32x32_bf16 v[68:83], v[20:23], v[36:43], v84
    ds_read_b128 v[32:35], v86 offset:7424
    v_exp_f32 v47, v47
    v_exp_f32 v48, v48
    v_exp_f32 v49, v49
    v_exp_f32 v50, v50
    v_exp_f32 v51, v51
    v_exp_f32 v52, v52
    v_exp_f32 v53, v53
    v_smfmac_f32_32x32x32_bf16 v[68:83], v[24:27], v[44:51], v84
    s_waitcnt lgkmcnt(2)
    ds_read_b128 v[16:19], v85 offset:59392
    v_exp_f32 v54, v54
    v_exp_f32 v55, v55
    v_exp_f32 v56, v56
    v_exp_f32 v57, v57
    v_mfma_f32_32x32x16_bf16 v[36:51], v[12:15], v[8:11], 0
    s_waitcnt lgkmcnt(1)
    v_add_u32 v86, v87, v86
    ds_read_b128 v[20:23], v86 offset:1024
    v_exp_f32 v58, v58
    v_exp_f32 v59, v59
    v_exp_f32 v60, v60
    v_exp_f32 v61, v61
    v_exp_f32 v62, v62
    v_smfmac_f32_32x32x32_bf16 v[68:83], v[28:31], v[52:59], v84
    ds_read_b128 v[24:27], v86 offset:1280
    v_exp_f32 v63, v63
    v_exp_f32 v64, v64
    v_exp_f32 v65, v65
    v_exp_f32 v66, v66
    v_exp_f32 v67, v67
    v_exp_f32 v36, v36
    v_exp_f32 v37, v37
    v_smfmac_f32_32x32x32_bf16 v[68:83], v[32:35], v[60:67], v84
    s_waitcnt lgkmcnt(2)
    ds_read_b128 v[12:15], v85 offset:61440
    v_exp_f32 v38, v38
    v_exp_f32 v39, v39
    v_exp_f32 v40, v40
    v_exp_f32 v41, v41
    v_mfma_f32_32x32x16_bf16 v[52:67], v[16:19], v[8:11], 0
    s_waitcnt lgkmcnt(1)
    ds_read_b128 v[28:31], v86 offset:3072
    v_exp_f32 v42, v42
    v_exp_f32 v43, v43
    v_exp_f32 v44, v44
    v_exp_f32 v45, v45
    v_exp_f32 v46, v46
    v_smfmac_f32_32x32x32_bf16 v[68:83], v[20:23], v[36:43], v84
    ds_read_b128 v[32:35], v86 offset:3328
    v_exp_f32 v47, v47
    v_exp_f32 v48, v48
    v_exp_f32 v49, v49
    v_exp_f32 v50, v50
    v_exp_f32 v51, v51
    v_exp_f32 v52, v52
    v_exp_f32 v53, v53
    v_smfmac_f32_32x32x32_bf16 v[68:83], v[24:27], v[44:51], v84
    s_waitcnt lgkmcnt(2)
    ds_read_b128 v[16:19], v85 offset:63488
    v_exp_f32 v54, v54
    v_exp_f32 v55, v55
    v_exp_f32 v56, v56
    v_exp_f32 v57, v57
    v_mfma_f32_32x32x16_bf16 v[36:51], v[12:15], v[8:11], 0
    s_waitcnt lgkmcnt(1)
    ds_read_b128 v[20:23], v86 offset:5120
    v_exp_f32 v58, v58
    v_exp_f32 v59, v59
    v_exp_f32 v60, v60
    v_exp_f32 v61, v61
    v_exp_f32 v62, v62
    v_smfmac_f32_32x32x32_bf16 v[68:83], v[28:31], v[52:59], v84
    ds_read_b128 v[24:27], v86 offset:5376
    v_exp_f32 v63, v63
    v_exp_f32 v64, v64
    v_exp_f32 v65, v65
    v_exp_f32 v66, v66
    v_exp_f32 v67, v67
    v_exp_f32 v36, v36
    v_exp_f32 v37, v37
    v_smfmac_f32_32x32x32_bf16 v[68:83], v[32:35], v[60:67], v84
    s_waitcnt lgkmcnt(2)
    s_setprio 2
    v_add_u32 v85, 0x10000, v85
    ds_read_b128 v[12:15], v85 offset:0
    v_exp_f32 v38, v38
    v_exp_f32 v39, v39
    v_exp_f32 v40, v40
    v_exp_f32 v41, v41
    v_mfma_f32_32x32x16_bf16 v[52:67], v[16:19], v[8:11], 0
    s_waitcnt lgkmcnt(1)
    ds_read_b128 v[28:31], v86 offset:7168
    v_exp_f32 v42, v42
    v_exp_f32 v43, v43
    v_exp_f32 v44, v44
    v_exp_f32 v45, v45
    v_exp_f32 v46, v46
    v_smfmac_f32_32x32x32_bf16 v[68:83], v[20:23], v[36:43], v84
    ds_read_b128 v[32:35], v86 offset:7424
    v_exp_f32 v47, v47
    v_exp_f32 v48, v48
    v_exp_f32 v49, v49
    v_exp_f32 v50, v50
    v_exp_f32 v51, v51
    v_exp_f32 v52, v52
    v_exp_f32 v53, v53
    v_smfmac_f32_32x32x32_bf16 v[68:83], v[24:27], v[44:51], v84
    s_waitcnt lgkmcnt(2)
    ds_read_b128 v[16:19], v85 offset:2048
    v_exp_f32 v54, v54
    v_exp_f32 v55, v55
    v_exp_f32 v56, v56
    v_exp_f32 v57, v57
    v_mfma_f32_32x32x16_bf16 v[36:51], v[12:15], v[8:11], 0
    s_waitcnt lgkmcnt(1)
    v_add_u32 v86, v87, v86
    ds_read_b128 v[20:23], v86 offset:1024
    v_exp_f32 v58, v58
    v_exp_f32 v59, v59
    v_exp_f32 v60, v60
    v_exp_f32 v61, v61
    v_exp_f32 v62, v62
    v_smfmac_f32_32x32x32_bf16 v[68:83], v[28:31], v[52:59], v84
    ds_read_b128 v[24:27], v86 offset:1280
    v_exp_f32 v63, v63
    v_exp_f32 v64, v64
    v_exp_f32 v65, v65
    v_exp_f32 v66, v66
    v_exp_f32 v67, v67
    v_exp_f32 v36, v36
    v_exp_f32 v37, v37
    v_smfmac_f32_32x32x32_bf16 v[68:83], v[32:35], v[60:67], v84
    s_waitcnt lgkmcnt(2)
    ds_read_b128 v[12:15], v85 offset:4096
    v_exp_f32 v38, v38
    v_exp_f32 v39, v39
    v_exp_f32 v40, v40
    v_exp_f32 v41, v41
    v_mfma_f32_32x32x16_bf16 v[52:67], v[16:19], v[8:11], 0
    s_waitcnt lgkmcnt(1)
    ds_read_b128 v[28:31], v86 offset:3072
    v_exp_f32 v42, v42
    v_exp_f32 v43, v43
    v_exp_f32 v44, v44
    v_exp_f32 v45, v45
    v_exp_f32 v46, v46
    v_smfmac_f32_32x32x32_bf16 v[68:83], v[20:23], v[36:43], v84
    ds_read_b128 v[32:35], v86 offset:3328
    v_exp_f32 v47, v47
    v_exp_f32 v48, v48
    v_exp_f32 v49, v49
    v_exp_f32 v50, v50
    v_exp_f32 v51, v51
    s_lshl_b32 s41, s20, 2
    v_add_u32 v5, s41, v2
    s_lshr_b32 s41, s61, 1
    v_and_b32 v6, 16, v2
    v_cmp_gt_u32 vcc, 4, v2
    v_xor_b32 v6, s41, v6
    s_add_u32 s40, s70, 1024
    v_cndmask_b32 v5, v6, v5, vcc
    v_bfe_u32 v6, v5, 1, 2
    v_lshlrev_b32 v6, 6, v6
    v_bfe_u32 v7, v5, 3, 2
    v_lshl_add_u32 v6, v7, 4, v6
    v_and_b32 v5, 1, v5
    v_cndmask_b32 v7, 4, 0, vcc
    v_add3_u32 v5, v5, v6, v7
    v_add_u32 v5, s40, v5
    v_and_b32 v6, 31, v2
    s_lshl_b32 s40, s46, 3
    s_add_u32 s40, s40, s18
    s_add_u32 s40, s40, 1028
    v_cmp_gt_u32 vcc, 32, v2
    v_lshl_add_u32 v6, v6, 5, s40
    s_nop 0
    v_cndmask_b32 v5, v6, v5, vcc
    v_lshlrev_b32 v5, 7, v5
    v_add_u32 v88, 15728640, v5
    v_mov_b32 v92, -1
    v_mov_b32 v93, -1
    v_mov_b32 v94, -1
    v_mov_b32 v95, -1
    v_exp_f32 v52, v52
    v_exp_f32 v53, v53
    v_smfmac_f32_32x32x32_bf16 v[68:83], v[24:27], v[44:51], v84
    s_waitcnt lgkmcnt(2)
    ds_read_b128 v[16:19], v85 offset:6144
    v_exp_f32 v54, v54
    v_exp_f32 v55, v55
    v_exp_f32 v56, v56
    v_exp_f32 v57, v57
    v_mfma_f32_32x32x16_bf16 v[36:51], v[12:15], v[8:11], 0
    s_waitcnt lgkmcnt(1)
    ds_read_b128 v[20:23], v86 offset:5120
    v_exp_f32 v58, v58
    v_exp_f32 v59, v59
    v_exp_f32 v60, v60
    v_exp_f32 v61, v61
    v_exp_f32 v62, v62
    v_smfmac_f32_32x32x32_bf16 v[68:83], v[28:31], v[52:59], v84
    ds_read_b128 v[24:27], v86 offset:5376
    v_exp_f32 v63, v63
    v_exp_f32 v64, v64
    v_exp_f32 v65, v65
    v_exp_f32 v66, v66
    v_exp_f32 v67, v67
    v_exp_f32 v36, v36
    v_exp_f32 v37, v37
    v_smfmac_f32_32x32x32_bf16 v[68:83], v[32:35], v[60:67], v84
    s_waitcnt lgkmcnt(2)
    ds_read_b128 v[12:15], v85 offset:8192
    buffer_load_dword v89, v88, s[32:35], 0 offen sc1
    v_exp_f32 v38, v38
    v_exp_f32 v39, v39
    v_exp_f32 v40, v40
    v_exp_f32 v41, v41
    v_mfma_f32_32x32x16_bf16 v[52:67], v[16:19], v[8:11], 0
    s_waitcnt lgkmcnt(1)
    ds_read_b128 v[28:31], v86 offset:7168
    v_exp_f32 v42, v42
    v_exp_f32 v43, v43
    v_exp_f32 v44, v44
    v_exp_f32 v45, v45
    v_exp_f32 v46, v46
    v_smfmac_f32_32x32x32_bf16 v[68:83], v[20:23], v[36:43], v84
    ds_read_b128 v[32:35], v86 offset:7424
    v_exp_f32 v47, v47
    v_exp_f32 v48, v48
    v_exp_f32 v49, v49
    v_exp_f32 v50, v50
    v_exp_f32 v51, v51
    v_exp_f32 v52, v52
    v_exp_f32 v53, v53
    v_smfmac_f32_32x32x32_bf16 v[68:83], v[24:27], v[44:51], v84
    s_waitcnt lgkmcnt(2)
    ds_read_b128 v[16:19], v85 offset:10240
    buffer_store_dwordx4 v[92:95], v1, s[32:35], s51 offen sc1
    v_exp_f32 v54, v54
    v_exp_f32 v55, v55
    v_exp_f32 v56, v56
    v_exp_f32 v57, v57
    v_mfma_f32_32x32x16_bf16 v[36:51], v[12:15], v[8:11], 0
    s_waitcnt lgkmcnt(1)
    v_add_u32 v86, v87, v86
    ds_read_b128 v[20:23], v86 offset:1024
    v_exp_f32 v58, v58
    v_exp_f32 v59, v59
    v_exp_f32 v60, v60
    v_exp_f32 v61, v61
    v_exp_f32 v62, v62
    v_smfmac_f32_32x32x32_bf16 v[68:83], v[28:31], v[52:59], v84
    ds_read_b128 v[24:27], v86 offset:1280
    v_exp_f32 v63, v63
    v_exp_f32 v64, v64
    v_exp_f32 v65, v65
    v_exp_f32 v66, v66
    v_exp_f32 v67, v67
    s_waitcnt vmcnt(1)
    v_cmp_ne_u32 vcc, v3, v89
    s_cbranch_vccnz R_f2
C_f2:
    s_cmp_lg_u32 s69, 0
    s_cbranch_scc1 K_attB
    v_exp_f32 v36, v36
    v_exp_f32 v37, v37
    v_smfmac_f32_32x32x32_bf16 v[68:83], v[32:35], v[60:67], v84
    s_waitcnt lgkmcnt(2)
    s_setprio 1
    ds_read_b128 v[12:15], v85 offset:12288
    buffer_load_dwordx4 v[204:207], v1, s[32:35], s50 offen offset:0 sc1
    v_exp_f32 v38, v38
    v_exp_f32 v39, v39
    v_exp_f32 v40, v40
    v_exp_f32 v41, v41
    v_mfma_f32_32x32x16_bf16 v[52:67], v[16:19], v[8:11], 0
    s_waitcnt lgkmcnt(1)
    ds_read_b128 v[28:31], v86 offset:3072
    buffer_load_dwordx4 v[208:211], v1, s[32:35], s50 offen offset:1024 sc1
    v_exp_f32 v42, v42
    v_exp_f32 v43, v43
    v_exp_f32 v44, v44
    v_exp_f32 v45, v45
    v_exp_f32 v46, v46
    v_smfmac_f32_32x32x32_bf16 v[68:83], v[20:23], v[36:43], v84
    ds_read_b128 v[32:35], v86 offset:3328
    buffer_load_dwordx4 v[212:215], v1, s[32:35], s50 offen offset:2048 sc1
    v_exp_f32 v47, v47
    v_exp_f32 v48, v48
    v_exp_f32 v49, v49
    v_exp_f32 v50, v50
    v_exp_f32 v51, v51
    v_exp_f32 v52, v52
    v_exp_f32 v53, v53
    v_smfmac_f32_32x32x32_bf16 v[68:83], v[24:27], v[44:51], v84
    s_waitcnt lgkmcnt(2)
    ds_read_b128 v[16:19], v85 offset:14336
    buffer_load_dwordx4 v[216:219], v1, s[32:35], s50 offen offset:3072 sc1
    v_exp_f32 v54, v54
    v_exp_f32 v55, v55
    v_exp_f32 v56, v56
    v_exp_f32 v57, v57
    v_mfma_f32_32x32x16_bf16 v[36:51], v[12:15], v[8:11], 0
    s_waitcnt lgkmcnt(1)
    ds_read_b128 v[20:23], v86 offset:5120
    s_add_u32 s50, s50, 4096
    buffer_load_dwordx4 v[220:223], v1, s[32:35], s50 offen offset:0 sc1
    v_exp_f32 v58, v58
    v_exp_f32 v59, v59
    v_exp_f32 v60, v60
    v_exp_f32 v61, v61
    v_exp_f32 v62, v62
    v_smfmac_f32_32x32x32_bf16 v[68:83], v[28:31], v[52:59], v84
    ds_read_b128 v[24:27], v86 offset:5376
    buffer_load_dwordx4 v[224:227], v1, s[32:35], s50 offen offset:1024 sc1
    v_exp_f32 v63, v63
    v_exp_f32 v64, v64
    v_exp_f32 v65, v65
    v_exp_f32 v66, v66
    v_exp_f32 v67, v67
    v_exp_f32 v36, v36
    v_exp_f32 v37, v37
    v_smfmac_f32_32x32x32_bf16 v[68:83], v[32:35], v[60:67], v84
    s_waitcnt lgkmcnt(2)
    ds_read_b128 v[12:15], v85 offset:16384
    buffer_load_dwordx4 v[228:231], v1, s[32:35], s50 offen offset:2048 sc1
    v_exp_f32 v38, v38
    v_exp_f32 v39, v39
    v_exp_f32 v40, v40
    v_exp_f32 v41, v41
    v_mfma_f32_32x32x16_bf16 v[52:67], v[16:19], v[8:11], 0
    s_waitcnt lgkmcnt(1)
    ds_read_b128 v[28:31], v86 offset:7168
    buffer_load_dwordx4 v[232:235], v1, s[32:35], s50 offen offset:3072 sc1
    v_exp_f32 v42, v42
    v_exp_f32 v43, v43
    v_exp_f32 v44, v44
    v_exp_f32 v45, v45
    v_exp_f32 v46, v46
    v_smfmac_f32_32x32x32_bf16 v[68:83], v[20:23], v[36:43], v84
    ds_read_b128 v[32:35], v86 offset:7424
    buffer_load_dwordx4 v[236:239], v1, s[32:35], s49 offen sc1
    v_exp_f32 v47, v47
    v_exp_f32 v48, v48
    v_exp_f32 v49, v49
    v_exp_f32 v50, v50
    v_exp_f32 v51, v51
    v_exp_f32 v52, v52
    v_exp_f32 v53, v53
    v_smfmac_f32_32x32x32_bf16 v[68:83], v[24:27], v[44:51], v84
    s_waitcnt lgkmcnt(2)
    s_setprio 0
    s_add_u32 s49, s49, 32768
    ds_read_b128 v[16:19], v85 offset:18432
    buffer_load_dwordx4 v[240:243], v1, s[32:35], s49 offen sc1
    v_exp_f32 v54, v54
    v_exp_f32 v55, v55
    v_exp_f32 v56, v56
    v_exp_f32 v57, v57
    v_mfma_f32_32x32x16_bf16 v[36:51], v[12:15], v[8:11], 0
    s_waitcnt lgkmcnt(1)
    v_add_u32 v86, v87, v86
    ds_read_b128 v[20:23], v86 offset:1024
    v_exp_f32 v58, v58
    v_exp_f32 v59, v59
    v_exp_f32 v60, v60
    v_exp_f32 v61, v61
    v_exp_f32 v62, v62
    v_smfmac_f32_32x32x32_bf16 v[68:83], v[28:31], v[52:59], v84
    ds_read_b128 v[24:27], v86 offset:1280
    v_exp_f32 v63, v63
    v_exp_f32 v64, v64
    v_exp_f32 v65, v65
    v_exp_f32 v66, v66
    v_exp_f32 v67, v67
    s_waitcnt vmcnt(2)
    v_pk_add_f32 v[204:205], v[204:205], v[212:213]
    v_pk_add_f32 v[220:221], v[220:221], v[228:229]
    v_pk_add_f32 v[206:207], v[206:207], v[214:215]
    v_pk_add_f32 v[222:223], v[222:223], v[230:231]
    v_pk_add_f32 v[208:209], v[208:209], v[216:217]
    v_pk_add_f32 v[224:225], v[224:225], v[232:233]
    v_pk_add_f32 v[210:211], v[210:211], v[218:219]
    v_pk_add_f32 v[226:227], v[226:227], v[234:235]
    s_lshl_b32 s40, s20, 10
    s_add_u32 s40, s40, 147456
    v_add_u32 v6, s40, v1
    v_add_u32 v5, 147456, v1
    v_pk_add_f32 v[204:205], v[204:205], v[220:221]
    v_pk_add_f32 v[206:207], v[206:207], v[222:223]
    v_pk_add_f32 v[208:209], v[208:209], v[224:225]
    v_pk_add_f32 v[210:211], v[210:211], v[226:227]
    v_cvt_pk_bf16_f32 v212, v204, v205
    v_cvt_pk_bf16_f32 v213, v206, v207
    v_cvt_pk_bf16_f32 v214, v208, v209
    v_cvt_pk_bf16_f32 v215, v210, v211
    ds_write_b128 v6, v[212:215]
    v_exp_f32 v36, v36
    v_exp_f32 v37, v37
    v_smfmac_f32_32x32x32_bf16 v[68:83], v[32:35], v[60:67], v84
    s_waitcnt lgkmcnt(2)
    ds_read_b128 v[12:15], v85 offset:20480
    buffer_load_dwordx4 v[112:115], v1, s[32:35], s48 offen offset:0 sc1
    v_exp_f32 v38, v38
    v_exp_f32 v39, v39
    v_exp_f32 v40, v40
    v_exp_f32 v41, v41
    v_mfma_f32_32x32x16_bf16 v[52:67], v[16:19], v[8:11], 0
    s_waitcnt lgkmcnt(1)
    ds_read_b128 v[28:31], v86 offset:3072
    v_exp_f32 v42, v42
    v_exp_f32 v43, v43
    v_exp_f32 v44, v44
    v_exp_f32 v45, v45
    v_exp_f32 v46, v46
    v_smfmac_f32_32x32x32_bf16 v[68:83], v[20:23], v[36:43], v84
    ds_read_b128 v[32:35], v86 offset:3328
    buffer_load_dwordx4 v[116:119], v1, s[32:35], s48 offen offset:1024 sc1
    v_exp_f32 v47, v47
    v_exp_f32 v48, v48
    v_exp_f32 v49, v49
    v_exp_f32 v50, v50
    v_exp_f32 v51, v51
    s_waitcnt lgkmcnt(0)
    s_barrier
    ds_read_b128 v[204:207], v5 offset:0
    ds_read_b128 v[208:211], v5 offset:1024
    ds_read_b128 v[212:215], v5 offset:2048
    ds_read_b128 v[216:219], v5 offset:3072
    ds_read_b128 v[220:223], v5 offset:4096
    ds_read_b128 v[224:227], v5 offset:5120
    ds_read_b128 v[228:231], v5 offset:6144
    ds_read_b128 v[232:235], v5 offset:7168
    v_and_b32 v6, 3, v2
    s_bfe_u32 s40, s45, 0x20003
    s_lshl_b32 s40, s40, 5
    s_add_u32 s40, s40, s20
    s_lshl_b32 s40, s40, 3
    s_and_b32 s41, s45, 7
    s_add_u32 s40, s40, s41
    v_lshl_add_u32 v6, v6, 6, s40
    s_and_b32 s41, s45, 32
    s_lshl_b32 s41, s41, 3
    v_not_b32 v7, v2
    v_and_b32 v7, 4, v7
    v_mad_u32_u24 v6, v7, s41, v6
    v_lshlrev_b32 v6, 7, v6
    v_add_u32 v88, 16252928, v6
    v_exp_f32 v52, v52
    v_exp_f32 v53, v53
    v_smfmac_f32_32x32x32_bf16 v[68:83], v[24:27], v[44:51], v84
    s_waitcnt lgkmcnt(2)
    s_setprio 3
    ds_read_b128 v[16:19], v85 offset:22528
    buffer_load_dwordx4 v[120:123], v1, s[32:35], s48 offen offset:2048 sc1
    v_exp_f32 v54, v54
    v_exp_f32 v55, v55
    v_exp_f32 v56, v56
    v_exp_f32 v57, v57
    v_mfma_f32_32x32x16_bf16 v[36:51], v[12:15], v[8:11], 0
    s_waitcnt lgkmcnt(1)
    ds_read_b128 v[20:23], v86 offset:5120
    v_exp_f32 v58, v58
    v_exp_f32 v59, v59
    v_exp_f32 v60, v60
    v_exp_f32 v61, v61
    v_exp_f32 v62, v62
    v_smfmac_f32_32x32x32_bf16 v[68:83], v[28:31], v[52:59], v84
    ds_read_b128 v[24:27], v86 offset:5376
    buffer_load_dwordx4 v[124:127], v1, s[32:35], s48 offen offset:3072 sc1
    v_exp_f32 v63, v63
    v_exp_f32 v64, v64
    v_exp_f32 v65, v65
    v_exp_f32 v66, v66
    v_exp_f32 v67, v67
    s_waitcnt vmcnt(4)
    v_exp_f32 v36, v36
    v_exp_f32 v37, v37
    v_smfmac_f32_32x32x32_bf16 v[68:83], v[32:35], v[60:67], v84
    s_waitcnt lgkmcnt(2)
    s_add_u32 s48, s48, 4096
    ds_read_b128 v[12:15], v85 offset:24576
    buffer_load_dwordx4 v[128:131], v1, s[32:35], s48 offen offset:0 sc1
    v_exp_f32 v38, v38
    v_exp_f32 v39, v39
    v_mfma_f32_32x32x16_bf16 v[96:111], v[204:207], v[236:239], 0
    v_exp_f32 v40, v40
    v_exp_f32 v41, v41
    v_mfma_f32_32x32x16_bf16 v[52:67], v[16:19], v[8:11], 0
    s_waitcnt lgkmcnt(1)
    ds_read_b128 v[28:31], v86 offset:7168
    v_exp_f32 v42, v42
    v_exp_f32 v43, v43
    v_exp_f32 v44, v44
    v_mfma_f32_32x32x16_bf16 v[96:111], v[208:211], v[236:239], v[96:111]
    v_exp_f32 v45, v45
    v_exp_f32 v46, v46
    v_smfmac_f32_32x32x32_bf16 v[68:83], v[20:23], v[36:43], v84
    ds_read_b128 v[32:35], v86 offset:7424
    buffer_load_dwordx4 v[132:135], v1, s[32:35], s48 offen offset:1024 sc1
    v_exp_f32 v47, v47
    v_exp_f32 v48, v48
    v_mfma_f32_32x32x16_bf16 v[96:111], v[212:215], v[236:239], v[96:111]
    v_exp_f32 v49, v49
    v_exp_f32 v50, v50
    v_mfma_f32_32x32x16_bf16 v[96:111], v[216:219], v[236:239], v[96:111]
    v_exp_f32 v51, v51
    v_exp_f32 v52, v52
    v_exp_f32 v53, v53
    v_smfmac_f32_32x32x32_bf16 v[68:83], v[24:27], v[44:51], v84
    s_waitcnt lgkmcnt(2)
    ds_read_b128 v[16:19], v85 offset:26624
    buffer_load_dwordx4 v[136:139], v1, s[32:35], s48 offen offset:2048 sc1
    v_exp_f32 v54, v54
    v_exp_f32 v55, v55
    v_mfma_f32_32x32x16_bf16 v[96:111], v[220:223], v[236:239], v[96:111]
    v_exp_f32 v56, v56
    v_exp_f32 v57, v57
    v_mfma_f32_32x32x16_bf16 v[36:51], v[12:15], v[8:11], 0
    s_waitcnt lgkmcnt(1)
    v_add_u32 v86, v87, v86
    ds_read_b128 v[20:23], v86 offset:1024
    v_exp_f32 v58, v58
    v_exp_f32 v59, v59
    v_exp_f32 v60, v60
    v_mfma_f32_32x32x16_bf16 v[96:111], v[224:227], v[236:239], v[96:111]
    v_exp_f32 v61, v61
    v_exp_f32 v62, v62
    v_smfmac_f32_32x32x32_bf16 v[68:83], v[28:31], v[52:59], v84
    ds_read_b128 v[24:27], v86 offset:1280
    buffer_load_dwordx4 v[140:143], v1, s[32:35], s48 offen offset:3072 sc1
    v_exp_f32 v63, v63
    v_exp_f32 v64, v64
    v_mfma_f32_32x32x16_bf16 v[96:111], v[228:231], v[236:239], v[96:111]
    v_exp_f32 v65, v65
    v_exp_f32 v66, v66
    v_mfma_f32_32x32x16_bf16 v[96:111], v[232:235], v[236:239], v[96:111]
    v_exp_f32 v67, v67
    v_exp_f32 v36, v36
    v_exp_f32 v37, v37
    v_smfmac_f32_32x32x32_bf16 v[68:83], v[32:35], v[60:67], v84
    s_waitcnt lgkmcnt(2)
    s_add_u32 s48, s48, 4096
    ds_read_b128 v[12:15], v85 offset:28672
    buffer_load_dwordx4 v[144:147], v1, s[32:35], s48 offen offset:0 sc1
    v_exp_f32 v38, v38
    v_exp_f32 v39, v39
    v_exp_f32 v40, v40
    v_exp_f32 v41, v41
    v_mfma_f32_32x32x16_bf16 v[52:67], v[16:19], v[8:11], 0
    s_waitcnt lgkmcnt(1)
    ds_read_b128 v[28:31], v86 offset:3072
    v_exp_f32 v42, v42
    v_exp_f32 v43, v43
    v_exp_f32 v44, v44
    v_exp_f32 v45, v45
    v_exp_f32 v46, v46
    v_smfmac_f32_32x32x32_bf16 v[68:83], v[20:23], v[36:43], v84
    ds_read_b128 v[32:35], v86 offset:3328
    buffer_load_dwordx4 v[148:151], v1, s[32:35], s48 offen offset:1024 sc1
    v_exp_f32 v47, v47
    v_exp_f32 v48, v48
    v_exp_f32 v49, v49
    v_exp_f32 v50, v50
    v_exp_f32 v51, v51
    v_add_f32 v104, 897988541, v104
    v_rcp_f32 v104, v104
    s_nop 0
    v_mul_f32 v96, v96, v104
    v_mul_f32 v97, v97, v104
    v_mul_f32 v98, v98, v104
    v_mul_f32 v99, v99, v104
    v_mul_f32 v100, v100, v104
    v_mul_f32 v101, v101, v104
    v_mul_f32 v102, v102, v104
    v_mul_f32 v103, v103, v104
    v_cvt_pk_bf16_f32 v92, v96, v97
    v_cvt_pk_bf16_f32 v93, v98, v99
    v_cvt_pk_bf16_f32 v94, v100, v101
    v_cvt_pk_bf16_f32 v95, v102, v103
    v_exp_f32 v52, v52
    v_exp_f32 v53, v53
    v_smfmac_f32_32x32x32_bf16 v[68:83], v[24:27], v[44:51], v84
    s_waitcnt lgkmcnt(2)
    ds_read_b128 v[16:19], v85 offset:30720
    buffer_store_dwordx4 v[92:95], v1, s[32:35], s55 offen sc1
    v_exp_f32 v54, v54
    v_exp_f32 v55, v55
    v_exp_f32 v56, v56
    v_exp_f32 v57, v57
    v_mfma_f32_32x32x16_bf16 v[36:51], v[12:15], v[8:11], 0
    s_waitcnt lgkmcnt(1)
    ds_read_b128 v[20:23], v86 offset:5120
    v_exp_f32 v58, v58
    v_exp_f32 v59, v59
    v_exp_f32 v60, v60
    v_exp_f32 v61, v61
    v_exp_f32 v62, v62
    v_smfmac_f32_32x32x32_bf16 v[68:83], v[28:31], v[52:59], v84
    ds_read_b128 v[24:27], v86 offset:5376
    v_exp_f32 v63, v63
    v_exp_f32 v64, v64
    v_exp_f32 v65, v65
    v_exp_f32 v66, v66
    v_exp_f32 v67, v67
    v_exp_f32 v36, v36
    v_exp_f32 v37, v37
    v_smfmac_f32_32x32x32_bf16 v[68:83], v[32:35], v[60:67], v84
    s_waitcnt lgkmcnt(2)
    ds_read_b128 v[12:15], v85 offset:32768
    buffer_load_dwordx4 v[152:155], v1, s[32:35], s48 offen offset:2048 sc1
    v_exp_f32 v38, v38
    v_exp_f32 v39, v39
    v_mfma_f32_32x32x16_bf16 v[96:111], v[204:207], v[240:243], 0
    v_exp_f32 v40, v40
    v_exp_f32 v41, v41
    v_mfma_f32_32x32x16_bf16 v[52:67], v[16:19], v[8:11], 0
    s_waitcnt lgkmcnt(1)
    ds_read_b128 v[28:31], v86 offset:7168
    v_exp_f32 v42, v42
    v_exp_f32 v43, v43
    v_exp_f32 v44, v44
    v_mfma_f32_32x32x16_bf16 v[96:111], v[208:211], v[240:243], v[96:111]
    v_exp_f32 v45, v45
    v_exp_f32 v46, v46
    v_smfmac_f32_32x32x32_bf16 v[68:83], v[20:23], v[36:43], v84
    ds_read_b128 v[32:35], v86 offset:7424
    buffer_load_dwordx4 v[156:159], v1, s[32:35], s48 offen offset:3072 sc1
    v_exp_f32 v47, v47
    v_exp_f32 v48, v48
    v_mfma_f32_32x32x16_bf16 v[96:111], v[212:215], v[240:243], v[96:111]
    v_exp_f32 v49, v49
    v_exp_f32 v50, v50
    v_mfma_f32_32x32x16_bf16 v[96:111], v[216:219], v[240:243], v[96:111]
    v_exp_f32 v51, v51
    v_exp_f32 v52, v52
    v_exp_f32 v53, v53
    v_smfmac_f32_32x32x32_bf16 v[68:83], v[24:27], v[44:51], v84
    s_waitcnt lgkmcnt(2)
    s_add_u32 s48, s48, 4096
    ds_read_b128 v[16:19], v85 offset:34816
    buffer_load_dwordx4 v[160:163], v1, s[32:35], s48 offen offset:0 sc1
    v_exp_f32 v54, v54
    v_exp_f32 v55, v55
    v_mfma_f32_32x32x16_bf16 v[96:111], v[220:223], v[240:243], v[96:111]
    v_exp_f32 v56, v56
    v_exp_f32 v57, v57
    v_mfma_f32_32x32x16_bf16 v[36:51], v[12:15], v[8:11], 0
    s_waitcnt lgkmcnt(1)
    v_add_u32 v86, v87, v86
    ds_read_b128 v[20:23], v86 offset:1024
    v_exp_f32 v58, v58
    v_exp_f32 v59, v59
    v_exp_f32 v60, v60
    v_mfma_f32_32x32x16_bf16 v[96:111], v[224:227], v[240:243], v[96:111]
    v_exp_f32 v61, v61
    v_exp_f32 v62, v62
    v_smfmac_f32_32x32x32_bf16 v[68:83], v[28:31], v[52:59], v84
    ds_read_b128 v[24:27], v86 offset:1280
    buffer_load_dwordx4 v[164:167], v1, s[32:35], s48 offen offset:1024 sc1
    v_exp_f32 v63, v63
    v_exp_f32 v64, v64
    v_mfma_f32_32x32x16_bf16 v[96:111], v[228:231], v[240:243], v[96:111]
    v_exp_f32 v65, v65
    v_exp_f32 v66, v66
    v_mfma_f32_32x32x16_bf16 v[96:111], v[232:235], v[240:243], v[96:111]
    v_exp_f32 v67, v67
    v_exp_f32 v36, v36
    v_exp_f32 v37, v37
    v_smfmac_f32_32x32x32_bf16 v[68:83], v[32:35], v[60:67], v84
    s_waitcnt lgkmcnt(2)
    ds_read_b128 v[12:15], v85 offset:36864
    buffer_load_dwordx4 v[168:171], v1, s[32:35], s48 offen offset:2048 sc1
    v_exp_f32 v38, v38
    v_exp_f32 v39, v39
    v_exp_f32 v40, v40
    v_exp_f32 v41, v41
    v_mfma_f32_32x32x16_bf16 v[52:67], v[16:19], v[8:11], 0
    s_waitcnt lgkmcnt(1)
    ds_read_b128 v[28:31], v86 offset:3072
    v_exp_f32 v42, v42
    v_exp_f32 v43, v43
    v_exp_f32 v44, v44
    v_exp_f32 v45, v45
    v_exp_f32 v46, v46
    v_smfmac_f32_32x32x32_bf16 v[68:83], v[20:23], v[36:43], v84
    ds_read_b128 v[32:35], v86 offset:3328
    buffer_load_dwordx4 v[172:175], v1, s[32:35], s48 offen offset:3072 sc1
    v_exp_f32 v47, v47
    v_exp_f32 v48, v48
    v_exp_f32 v49, v49
    v_exp_f32 v50, v50
    v_exp_f32 v51, v51
    v_add_f32 v104, 897988541, v104
    v_rcp_f32 v104, v104
    s_nop 0
    v_mul_f32 v96, v96, v104
    v_mul_f32 v97, v97, v104
    v_mul_f32 v98, v98, v104
    v_mul_f32 v99, v99, v104
    v_mul_f32 v100, v100, v104
    v_mul_f32 v101, v101, v104
    v_mul_f32 v102, v102, v104
    v_mul_f32 v103, v103, v104
    v_cvt_pk_bf16_f32 v92, v96, v97
    v_cvt_pk_bf16_f32 v93, v98, v99
    v_cvt_pk_bf16_f32 v94, v100, v101
    v_cvt_pk_bf16_f32 v95, v102, v103
    v_exp_f32 v52, v52
    v_exp_f32 v53, v53
    v_smfmac_f32_32x32x32_bf16 v[68:83], v[24:27], v[44:51], v84
    s_waitcnt lgkmcnt(2)
    s_add_u32 s55, s55, 0x100000
    ds_read_b128 v[16:19], v85 offset:38912
    buffer_store_dwordx4 v[92:95], v1, s[32:35], s55 offen sc1
    v_exp_f32 v54, v54
    v_exp_f32 v55, v55
    v_exp_f32 v56, v56
    v_exp_f32 v57, v57
    v_mfma_f32_32x32x16_bf16 v[36:51], v[12:15], v[8:11], 0
    s_waitcnt lgkmcnt(1)
    ds_read_b128 v[20:23], v86 offset:5120
    v_exp_f32 v58, v58
    v_exp_f32 v59, v59
    v_exp_f32 v60, v60
    v_exp_f32 v61, v61
    v_exp_f32 v62, v62
    v_smfmac_f32_32x32x32_bf16 v[68:83], v[28:31], v[52:59], v84
    ds_read_b128 v[24:27], v86 offset:5376
    v_exp_f32 v63, v63
    v_exp_f32 v64, v64
    v_exp_f32 v65, v65
    v_exp_f32 v66, v66
    v_exp_f32 v67, v67
    s_branch K_attJ
K_attB:
    v_exp_f32 v36, v36
    v_exp_f32 v37, v37
    v_smfmac_f32_32x32x32_bf16 v[68:83], v[32:35], v[60:67], v84
    s_waitcnt lgkmcnt(2)
    ds_read_b128 v[12:15], v85 offset:12288
    v_exp_f32 v38, v38
    v_exp_f32 v39, v39
    v_exp_f32 v40, v40
    v_exp_f32 v41, v41
    v_mfma_f32_32x32x16_bf16 v[52:67], v[16:19], v[8:11], 0
    s_waitcnt lgkmcnt(1)
    ds_read_b128 v[28:31], v86 offset:3072
    v_exp_f32 v42, v42
    v_exp_f32 v43, v43
    v_exp_f32 v44, v44
    v_exp_f32 v45, v45
    v_exp_f32 v46, v46
    v_smfmac_f32_32x32x32_bf16 v[68:83], v[20:23], v[36:43], v84
    ds_read_b128 v[32:35], v86 offset:3328
    v_exp_f32 v47, v47
    v_exp_f32 v48, v48
    v_exp_f32 v49, v49
    v_exp_f32 v50, v50
    v_exp_f32 v51, v51
    v_exp_f32 v52, v52
    v_exp_f32 v53, v53
    v_smfmac_f32_32x32x32_bf16 v[68:83], v[24:27], v[44:51], v84
    s_waitcnt lgkmcnt(2)
    ds_read_b128 v[16:19], v85 offset:14336
    v_exp_f32 v54, v54
    v_exp_f32 v55, v55
    v_exp_f32 v56, v56
    v_exp_f32 v57, v57
    v_mfma_f32_32x32x16_bf16 v[36:51], v[12:15], v[8:11], 0
    s_waitcnt lgkmcnt(1)
    ds_read_b128 v[20:23], v86 offset:5120
    v_exp_f32 v58, v58
    v_exp_f32 v59, v59
    v_exp_f32 v60, v60
    v_exp_f32 v61, v61
    v_exp_f32 v62, v62
    v_smfmac_f32_32x32x32_bf16 v[68:83], v[28:31], v[52:59], v84
    ds_read_b128 v[24:27], v86 offset:5376
    v_exp_f32 v63, v63
    v_exp_f32 v64, v64
    v_exp_f32 v65, v65
    v_exp_f32 v66, v66
    v_exp_f32 v67, v67
    v_exp_f32 v36, v36
    v_exp_f32 v37, v37
    v_smfmac_f32_32x32x32_bf16 v[68:83], v[32:35], v[60:67], v84
    s_waitcnt lgkmcnt(2)
    ds_read_b128 v[12:15], v85 offset:16384
    v_exp_f32 v38, v38
    v_exp_f32 v39, v39
    v_exp_f32 v40, v40
    v_exp_f32 v41, v41
    v_mfma_f32_32x32x16_bf16 v[52:67], v[16:19], v[8:11], 0
    s_waitcnt lgkmcnt(1)
    ds_read_b128 v[28:31], v86 offset:7168
    v_exp_f32 v42, v42
    v_exp_f32 v43, v43
    v_exp_f32 v44, v44
    v_exp_f32 v45, v45
    v_exp_f32 v46, v46
    v_smfmac_f32_32x32x32_bf16 v[68:83], v[20:23], v[36:43], v84
    ds_read_b128 v[32:35], v86 offset:7424
    v_exp_f32 v47, v47
    v_exp_f32 v48, v48
    v_exp_f32 v49, v49
    v_exp_f32 v50, v50
    v_exp_f32 v51, v51
    v_exp_f32 v52, v52
    v_exp_f32 v53, v53
    v_smfmac_f32_32x32x32_bf16 v[68:83], v[24:27], v[44:51], v84
    s_waitcnt lgkmcnt(2)
    ds_read_b128 v[16:19], v85 offset:18432
    v_exp_f32 v54, v54
    v_exp_f32 v55, v55
    v_exp_f32 v56, v56
    v_exp_f32 v57, v57
    v_mfma_f32_32x32x16_bf16 v[36:51], v[12:15], v[8:11], 0
    s_waitcnt lgkmcnt(1)
    v_add_u32 v86, v87, v86
    ds_read_b128 v[20:23], v86 offset:1024
    v_exp_f32 v58, v58
    v_exp_f32 v59, v59
    v_exp_f32 v60, v60
    v_exp_f32 v61, v61
    v_exp_f32 v62, v62
    v_smfmac_f32_32x32x32_bf16 v[68:83], v[28:31], v[52:59], v84
    ds_read_b128 v[24:27], v86 offset:1280
    v_exp_f32 v63, v63
    v_exp_f32 v64, v64
    v_exp_f32 v65, v65
    v_exp_f32 v66, v66
    v_exp_f32 v67, v67
    v_exp_f32 v36, v36
    v_exp_f32 v37, v37
    v_smfmac_f32_32x32x32_bf16 v[68:83], v[32:35], v[60:67], v84
    s_waitcnt lgkmcnt(2)
    ds_read_b128 v[12:15], v85 offset:20480
    buffer_load_dwordx4 v[112:115], v1, s[32:35], s48 offen offset:0 sc1
    v_exp_f32 v38, v38
    v_exp_f32 v39, v39
    v_exp_f32 v40, v40
    v_exp_f32 v41, v41
    v_mfma_f32_32x32x16_bf16 v[52:67], v[16:19], v[8:11], 0
    s_waitcnt lgkmcnt(1)
    ds_read_b128 v[28:31], v86 offset:3072
    v_exp_f32 v42, v42
    v_exp_f32 v43, v43
    v_exp_f32 v44, v44
    v_exp_f32 v45, v45
    v_exp_f32 v46, v46
    v_smfmac_f32_32x32x32_bf16 v[68:83], v[20:23], v[36:43], v84
    ds_read_b128 v[32:35], v86 offset:3328
    buffer_load_dwordx4 v[116:119], v1, s[32:35], s48 offen offset:1024 sc1
    v_exp_f32 v47, v47
    v_exp_f32 v48, v48
    v_exp_f32 v49, v49
    v_exp_f32 v50, v50
    v_exp_f32 v51, v51
    v_and_b32 v6, 3, v2
    s_bfe_u32 s40, s45, 0x20003
    s_lshl_b32 s40, s40, 5
    s_add_u32 s40, s40, s20
    s_lshl_b32 s40, s40, 3
    s_and_b32 s41, s45, 7
    s_add_u32 s40, s40, s41
    v_lshl_add_u32 v6, v6, 6, s40
    s_and_b32 s41, s45, 32
    s_lshl_b32 s41, s41, 3
    v_not_b32 v7, v2
    v_and_b32 v7, 4, v7
    v_mad_u32_u24 v6, v7, s41, v6
    v_lshlrev_b32 v6, 7, v6
    v_add_u32 v88, 16252928, v6
    v_exp_f32 v52, v52
    v_exp_f32 v53, v53
    v_smfmac_f32_32x32x32_bf16 v[68:83], v[24:27], v[44:51], v84
    s_waitcnt lgkmcnt(2)
    s_setprio 3
    ds_read_b128 v[16:19], v85 offset:22528
    buffer_load_dwordx4 v[120:123], v1, s[32:35], s48 offen offset:2048 sc1
    v_exp_f32 v54, v54
    v_exp_f32 v55, v55
    v_exp_f32 v56, v56
    v_exp_f32 v57, v57
    v_mfma_f32_32x32x16_bf16 v[36:51], v[12:15], v[8:11], 0
    s_waitcnt lgkmcnt(1)
    ds_read_b128 v[20:23], v86 offset:5120
    v_exp_f32 v58, v58
    v_exp_f32 v59, v59
    v_exp_f32 v60, v60
    v_exp_f32 v61, v61
    v_exp_f32 v62, v62
    v_smfmac_f32_32x32x32_bf16 v[68:83], v[28:31], v[52:59], v84
    ds_read_b128 v[24:27], v86 offset:5376
    buffer_load_dwordx4 v[124:127], v1, s[32:35], s48 offen offset:3072 sc1
    v_exp_f32 v63, v63
    v_exp_f32 v64, v64
    v_exp_f32 v65, v65
    v_exp_f32 v66, v66
    v_exp_f32 v67, v67
    v_exp_f32 v36, v36
    v_exp_f32 v37, v37
    v_smfmac_f32_32x32x32_bf16 v[68:83], v[32:35], v[60:67], v84
    s_waitcnt lgkmcnt(2)
    s_add_u32 s48, s48, 4096
    ds_read_b128 v[12:15], v85 offset:24576
    buffer_load_dwordx4 v[128:131], v1, s[32:35], s48 offen offset:0 sc1
    v_exp_f32 v38, v38
    v_exp_f32 v39, v39
    v_exp_f32 v40, v40
    v_exp_f32 v41, v41
    v_mfma_f32_32x32x16_bf16 v[52:67], v[16:19], v[8:11], 0
    s_waitcnt lgkmcnt(1)
    ds_read_b128 v[28:31], v86 offset:7168
    v_exp_f32 v42, v42
    v_exp_f32 v43, v43
    v_exp_f32 v44, v44
    v_exp_f32 v45, v45
    v_exp_f32 v46, v46
    v_smfmac_f32_32x32x32_bf16 v[68:83], v[20:23], v[36:43], v84
    ds_read_b128 v[32:35], v86 offset:7424
    buffer_load_dwordx4 v[132:135], v1, s[32:35], s48 offen offset:1024 sc1
    v_exp_f32 v47, v47
    v_exp_f32 v48, v48
    v_exp_f32 v49, v49
    v_exp_f32 v50, v50
    v_exp_f32 v51, v51
    s_waitcnt vmcnt(6)
    s_add_u32 s66, s64, 16252928
    s_mov_b64 exec, 1
    v_mov_b32 v4, 0
    buffer_store_dword v3, v4, s[32:35], s66 offen sc1
    s_mov_b64 exec, -1
    v_exp_f32 v52, v52
    v_exp_f32 v53, v53
    v_smfmac_f32_32x32x32_bf16 v[68:83], v[24:27], v[44:51], v84
    s_waitcnt lgkmcnt(2)
    ds_read_b128 v[16:19], v85 offset:26624
    buffer_load_dwordx4 v[136:139], v1, s[32:35], s48 offen offset:2048 sc1
    v_exp_f32 v54, v54
    v_exp_f32 v55, v55
    v_exp_f32 v56, v56
    v_exp_f32 v57, v57
    v_mfma_f32_32x32x16_bf16 v[36:51], v[12:15], v[8:11], 0
    s_waitcnt lgkmcnt(1)
    v_add_u32 v86, v87, v86
    ds_read_b128 v[20:23], v86 offset:1024
    v_exp_f32 v58, v58
    v_exp_f32 v59, v59
    v_exp_f32 v60, v60
    v_exp_f32 v61, v61
    v_exp_f32 v62, v62
    v_smfmac_f32_32x32x32_bf16 v[68:83], v[28:31], v[52:59], v84
    ds_read_b128 v[24:27], v86 offset:1280
    buffer_load_dwordx4 v[140:143], v1, s[32:35], s48 offen offset:3072 sc1
    v_exp_f32 v63, v63
    v_exp_f32 v64, v64
    v_exp_f32 v65, v65
    v_exp_f32 v66, v66
    v_exp_f32 v67, v67
    v_exp_f32 v36, v36
    v_exp_f32 v37, v37
    v_smfmac_f32_32x32x32_bf16 v[68:83], v[32:35], v[60:67], v84
    s_waitcnt lgkmcnt(2)
    s_add_u32 s48, s48, 4096
    ds_read_b128 v[12:15], v85 offset:28672
    buffer_load_dwordx4 v[144:147], v1, s[32:35], s48 offen offset:0 sc1
    v_exp_f32 v38, v38
    v_exp_f32 v39, v39
    v_exp_f32 v40, v40
    v_exp_f32 v41, v41
    v_mfma_f32_32x32x16_bf16 v[52:67], v[16:19], v[8:11], 0
    s_waitcnt lgkmcnt(1)
    ds_read_b128 v[28:31], v86 offset:3072
    v_exp_f32 v42, v42
    v_exp_f32 v43, v43
    v_exp_f32 v44, v44
    v_exp_f32 v45, v45
    v_exp_f32 v46, v46
    v_smfmac_f32_32x32x32_bf16 v[68:83], v[20:23], v[36:43], v84
    ds_read_b128 v[32:35], v86 offset:3328
    buffer_load_dwordx4 v[148:151], v1, s[32:35], s48 offen offset:1024 sc1
    v_exp_f32 v47, v47
    v_exp_f32 v48, v48
    v_exp_f32 v49, v49
    v_exp_f32 v50, v50
    v_exp_f32 v51, v51
    v_exp_f32 v52, v52
    v_exp_f32 v53, v53
    v_smfmac_f32_32x32x32_bf16 v[68:83], v[24:27], v[44:51], v84
    s_waitcnt lgkmcnt(2)
    ds_read_b128 v[16:19], v85 offset:30720
    v_exp_f32 v54, v54
    v_exp_f32 v55, v55
    v_exp_f32 v56, v56
    v_exp_f32 v57, v57
    v_mfma_f32_32x32x16_bf16 v[36:51], v[12:15], v[8:11], 0
    s_waitcnt lgkmcnt(1)
    ds_read_b128 v[20:23], v86 offset:5120
    v_exp_f32 v58, v58
    v_exp_f32 v59, v59
    v_exp_f32 v60, v60
    v_exp_f32 v61, v61
    v_exp_f32 v62, v62
    v_smfmac_f32_32x32x32_bf16 v[68:83], v[28:31], v[52:59], v84
    ds_read_b128 v[24:27], v86 offset:5376
    v_exp_f32 v63, v63
    v_exp_f32 v64, v64
    v_exp_f32 v65, v65
    v_exp_f32 v66, v66
    v_exp_f32 v67, v67
    v_exp_f32 v36, v36
    v_exp_f32 v37, v37
    v_smfmac_f32_32x32x32_bf16 v[68:83], v[32:35], v[60:67], v84
    s_waitcnt lgkmcnt(2)
    ds_read_b128 v[12:15], v85 offset:32768
    buffer_load_dwordx4 v[152:155], v1, s[32:35], s48 offen offset:2048 sc1
    v_exp_f32 v38, v38
    v_exp_f32 v39, v39
    v_exp_f32 v40, v40
    v_exp_f32 v41, v41
    v_mfma_f32_32x32x16_bf16 v[52:67], v[16:19], v[8:11], 0
    s_waitcnt lgkmcnt(1)
    ds_read_b128 v[28:31], v86 offset:7168
    v_exp_f32 v42, v42
    v_exp_f32 v43, v43
    v_exp_f32 v44, v44
    v_exp_f32 v45, v45
    v_exp_f32 v46, v46
    v_smfmac_f32_32x32x32_bf16 v[68:83], v[20:23], v[36:43], v84
    ds_read_b128 v[32:35], v86 offset:7424
    buffer_load_dwordx4 v[156:159], v1, s[32:35], s48 offen offset:3072 sc1
    v_exp_f32 v47, v47
    v_exp_f32 v48, v48
    v_exp_f32 v49, v49
    v_exp_f32 v50, v50
    v_exp_f32 v51, v51
    v_exp_f32 v52, v52
    v_exp_f32 v53, v53
    v_smfmac_f32_32x32x32_bf16 v[68:83], v[24:27], v[44:51], v84
    s_waitcnt lgkmcnt(2)
    s_add_u32 s48, s48, 4096
    ds_read_b128 v[16:19], v85 offset:34816
    buffer_load_dwordx4 v[160:163], v1, s[32:35], s48 offen offset:0 sc1
    v_exp_f32 v54, v54
    v_exp_f32 v55, v55
    v_exp_f32 v56, v56
    v_exp_f32 v57, v57
    v_mfma_f32_32x32x16_bf16 v[36:51], v[12:15], v[8:11], 0
    s_waitcnt lgkmcnt(1)
    v_add_u32 v86, v87, v86
    ds_read_b128 v[20:23], v86 offset:1024
    v_exp_f32 v58, v58
    v_exp_f32 v59, v59
    v_exp_f32 v60, v60
    v_exp_f32 v61, v61
    v_exp_f32 v62, v62
    v_smfmac_f32_32x32x32_bf16 v[68:83], v[28:31], v[52:59], v84
    ds_read_b128 v[24:27], v86 offset:1280
    buffer_load_dwordx4 v[164:167], v1, s[32:35], s48 offen offset:1024 sc1
    v_exp_f32 v63, v63
    v_exp_f32 v64, v64
    v_exp_f32 v65, v65
    v_exp_f32 v66, v66
    v_exp_f32 v67, v67
    v_exp_f32 v36, v36
    v_exp_f32 v37, v37
    v_smfmac_f32_32x32x32_bf16 v[68:83], v[32:35], v[60:67], v84
    s_waitcnt lgkmcnt(2)
    ds_read_b128 v[12:15], v85 offset:36864
    buffer_load_dwordx4 v[168:171], v1, s[32:35], s48 offen offset:2048 sc1
    v_exp_f32 v38, v38
    v_exp_f32 v39, v39
    v_exp_f32 v40, v40
    v_exp_f32 v41, v41
    v_mfma_f32_32x32x16_bf16 v[52:67], v[16:19], v[8:11], 0
    s_waitcnt lgkmcnt(1)
    ds_read_b128 v[28:31], v86 offset:3072
    v_exp_f32 v42, v42
    v_exp_f32 v43, v43
    v_exp_f32 v44, v44
    v_exp_f32 v45, v45
    v_exp_f32 v46, v46
    v_smfmac_f32_32x32x32_bf16 v[68:83], v[20:23], v[36:43], v84
    ds_read_b128 v[32:35], v86 offset:3328
    buffer_load_dwordx4 v[172:175], v1, s[32:35], s48 offen offset:3072 sc1
    v_exp_f32 v47, v47
    v_exp_f32 v48, v48
    v_exp_f32 v49, v49
    v_exp_f32 v50, v50
    v_exp_f32 v51, v51
    v_exp_f32 v52, v52
    v_exp_f32 v53, v53
    v_smfmac_f32_32x32x32_bf16 v[68:83], v[24:27], v[44:51], v84
    s_waitcnt lgkmcnt(2)
    ds_read_b128 v[16:19], v85 offset:38912
    v_exp_f32 v54, v54
    v_exp_f32 v55, v55
    v_exp_f32 v56, v56
    v_exp_f32 v57, v57
    v_mfma_f32_32x32x16_bf16 v[36:51], v[12:15], v[8:11], 0
    s_waitcnt lgkmcnt(1)
    ds_read_b128 v[20:23], v86 offset:5120
    v_exp_f32 v58, v58
    v_exp_f32 v59, v59
    v_exp_f32 v60, v60
    v_exp_f32 v61, v61
    v_exp_f32 v62, v62
    v_smfmac_f32_32x32x32_bf16 v[68:83], v[28:31], v[52:59], v84
    ds_read_b128 v[24:27], v86 offset:5376
    v_exp_f32 v63, v63
    v_exp_f32 v64, v64
    v_exp_f32 v65, v65
    v_exp_f32 v66, v66
    v_exp_f32 v67, v67
K_attJ:
    v_exp_f32 v36, v36
    v_exp_f32 v37, v37
    v_smfmac_f32_32x32x32_bf16 v[68:83], v[32:35], v[60:67], v84
    s_waitcnt lgkmcnt(2)
    s_add_u32 s48, s48, 4096
    ds_read_b128 v[12:15], v85 offset:40960
    buffer_load_dwordx4 v[176:179], v1, s[32:35], s48 offen offset:0 sc1
    v_exp_f32 v38, v38
    v_exp_f32 v39, v39
    v_exp_f32 v40, v40
    v_exp_f32 v41, v41
    v_mfma_f32_32x32x16_bf16 v[52:67], v[16:19], v[8:11], 0
    s_waitcnt lgkmcnt(1)
    ds_read_b128 v[28:31], v86 offset:7168
    v_exp_f32 v42, v42
    v_exp_f32 v43, v43
    v_exp_f32 v44, v44
    v_exp_f32 v45, v45
    v_exp_f32 v46, v46
    v_smfmac_f32_32x32x32_bf16 v[68:83], v[20:23], v[36:43], v84
    ds_read_b128 v[32:35], v86 offset:7424
    buffer_load_dwordx4 v[180:183], v1, s[32:35], s48 offen offset:1024 sc1
    v_exp_f32 v47, v47
    v_exp_f32 v48, v48
    v_exp_f32 v49, v49
    v_exp_f32 v50, v50
    v_exp_f32 v51, v51
    v_exp_f32 v52, v52
    v_exp_f32 v53, v53
    v_smfmac_f32_32x32x32_bf16 v[68:83], v[24:27], v[44:51], v84
    s_waitcnt lgkmcnt(2)
    ds_read_b128 v[16:19], v85 offset:43008
    buffer_load_dwordx4 v[184:187], v1, s[32:35], s48 offen offset:2048 sc1
    v_exp_f32 v54, v54
    v_exp_f32 v55, v55
    v_exp_f32 v56, v56
    v_exp_f32 v57, v57
    v_mfma_f32_32x32x16_bf16 v[36:51], v[12:15], v[8:11], 0
    s_waitcnt lgkmcnt(1)
    v_add_u32 v86, v87, v86
    ds_read_b128 v[20:23], v86 offset:1024
    v_exp_f32 v58, v58
    v_exp_f32 v59, v59
    v_exp_f32 v60, v60
    v_exp_f32 v61, v61
    v_exp_f32 v62, v62
    v_smfmac_f32_32x32x32_bf16 v[68:83], v[28:31], v[52:59], v84
    ds_read_b128 v[24:27], v86 offset:1280
    buffer_load_dwordx4 v[188:191], v1, s[32:35], s48 offen offset:3072 sc1
    v_exp_f32 v63, v63
    v_exp_f32 v64, v64
    v_exp_f32 v65, v65
    v_exp_f32 v66, v66
    v_exp_f32 v67, v67
    v_exp_f32 v36, v36
    v_exp_f32 v37, v37
    v_smfmac_f32_32x32x32_bf16 v[68:83], v[32:35], v[60:67], v84
    s_waitcnt lgkmcnt(2)
    s_add_u32 s48, s48, 4096
    ds_read_b128 v[12:15], v85 offset:45056
    buffer_load_dwordx4 v[192:195], v1, s[32:35], s48 offen offset:0 sc1
    v_exp_f32 v38, v38
    v_exp_f32 v39, v39
    v_exp_f32 v40, v40
    v_exp_f32 v41, v41
    v_mfma_f32_32x32x16_bf16 v[52:67], v[16:19], v[8:11], 0
    s_waitcnt lgkmcnt(1)
    ds_read_b128 v[28:31], v86 offset:3072
    v_exp_f32 v42, v42
    v_exp_f32 v43, v43
    v_exp_f32 v44, v44
    v_exp_f32 v45, v45
    v_exp_f32 v46, v46
    v_smfmac_f32_32x32x32_bf16 v[68:83], v[20:23], v[36:43], v84
    ds_read_b128 v[32:35], v86 offset:3328
    buffer_load_dwordx4 v[196:199], v1, s[32:35], s48 offen offset:1024 sc1
    v_exp_f32 v47, v47
    v_exp_f32 v48, v48
    v_exp_f32 v49, v49
    v_exp_f32 v50, v50
    v_exp_f32 v51, v51
    v_exp_f32 v52, v52
    v_exp_f32 v53, v53
    v_smfmac_f32_32x32x32_bf16 v[68:83], v[24:27], v[44:51], v84
    s_waitcnt lgkmcnt(2)
    s_setprio 2
    ds_read_b128 v[16:19], v85 offset:47104
    buffer_load_dwordx4 v[200:203], v1, s[32:35], s48 offen offset:2048 sc1
    v_exp_f32 v54, v54
    v_exp_f32 v55, v55
    v_exp_f32 v56, v56
    v_exp_f32 v57, v57
    v_mfma_f32_32x32x16_bf16 v[36:51], v[12:15], v[8:11], 0
    s_waitcnt lgkmcnt(1)
    ds_read_b128 v[20:23], v86 offset:5120
    v_exp_f32 v58, v58
    v_exp_f32 v59, v59
    v_exp_f32 v60, v60
    v_exp_f32 v61, v61
    v_exp_f32 v62, v62
    v_smfmac_f32_32x32x32_bf16 v[68:83], v[28:31], v[52:59], v84
    ds_read_b128 v[24:27], v86 offset:5376
    buffer_load_dwordx4 v[204:207], v1, s[32:35], s48 offen offset:3072 sc1
    v_exp_f32 v63, v63
    v_exp_f32 v64, v64
    v_exp_f32 v65, v65
    v_exp_f32 v66, v66
    v_exp_f32 v67, v67
    s_cmp_lg_u32 s69, 0
    s_cbranch_scc1 K_nof3
    s_waitcnt vmcnt(8)
    s_add_u32 s66, s64, 16252928
    s_mov_b64 exec, 1
    v_mov_b32 v4, 0
    buffer_store_dword v3, v4, s[32:35], s66 offen sc1
    s_mov_b64 exec, -1
K_nof3:
    v_exp_f32 v36, v36
    v_exp_f32 v37, v37
    v_smfmac_f32_32x32x32_bf16 v[68:83], v[32:35], v[60:67], v84
    s_waitcnt lgkmcnt(2)
    s_add_u32 s48, s48, 4096
    ds_read_b128 v[12:15], v85 offset:49152
    buffer_load_dwordx4 v[208:211], v1, s[32:35], s48 offen offset:0 sc1
    v_exp_f32 v38, v38
    v_exp_f32 v39, v39
    v_exp_f32 v40, v40
    v_exp_f32 v41, v41
    v_mfma_f32_32x32x16_bf16 v[52:67], v[16:19], v[8:11], 0
    s_waitcnt lgkmcnt(1)
    ds_read_b128 v[28:31], v86 offset:7168
    v_exp_f32 v42, v42
    v_exp_f32 v43, v43
    v_exp_f32 v44, v44
    v_exp_f32 v45, v45
    v_exp_f32 v46, v46
    v_smfmac_f32_32x32x32_bf16 v[68:83], v[20:23], v[36:43], v84
    ds_read_b128 v[32:35], v86 offset:7424
    buffer_load_dwordx4 v[212:215], v1, s[32:35], s48 offen offset:1024 sc1
    v_exp_f32 v47, v47
    v_exp_f32 v48, v48
    v_exp_f32 v49, v49
    v_exp_f32 v50, v50
    v_exp_f32 v51, v51
    v_exp_f32 v52, v52
    v_exp_f32 v53, v53
    v_smfmac_f32_32x32x32_bf16 v[68:83], v[24:27], v[44:51], v84
    s_waitcnt lgkmcnt(2)
    ds_read_b128 v[16:19], v85 offset:51200
    buffer_load_dwordx4 v[216:219], v1, s[32:35], s48 offen offset:2048 sc1
    v_exp_f32 v54, v54
    v_exp_f32 v55, v55
    v_exp_f32 v56, v56
    v_exp_f32 v57, v57
    v_mfma_f32_32x32x16_bf16 v[36:51], v[12:15], v[8:11], 0
    s_waitcnt lgkmcnt(1)
    v_add_u32 v86, v87, v86
    ds_read_b128 v[20:23], v86 offset:1024
    v_exp_f32 v58, v58
    v_exp_f32 v59, v59
    v_exp_f32 v60, v60
    v_exp_f32 v61, v61
    v_exp_f32 v62, v62
    v_smfmac_f32_32x32x32_bf16 v[68:83], v[28:31], v[52:59], v84
    ds_read_b128 v[24:27], v86 offset:1280
    buffer_load_dwordx4 v[220:223], v1, s[32:35], s48 offen offset:3072 sc1
    v_exp_f32 v63, v63
    v_exp_f32 v64, v64
    v_exp_f32 v65, v65
    v_exp_f32 v66, v66
    v_exp_f32 v67, v67
    v_exp_f32 v36, v36
    v_exp_f32 v37, v37
    v_smfmac_f32_32x32x32_bf16 v[68:83], v[32:35], v[60:67], v84
    s_waitcnt lgkmcnt(2)
    s_add_u32 s48, s48, 4096
    ds_read_b128 v[12:15], v85 offset:53248
    buffer_load_dwordx4 v[224:227], v1, s[32:35], s48 offen offset:0 sc1
    v_exp_f32 v38, v38
    v_exp_f32 v39, v39
    v_exp_f32 v40, v40
    v_exp_f32 v41, v41
    v_mfma_f32_32x32x16_bf16 v[52:67], v[16:19], v[8:11], 0
    s_waitcnt lgkmcnt(1)
    ds_read_b128 v[28:31], v86 offset:3072
    v_exp_f32 v42, v42
    v_exp_f32 v43, v43
    v_exp_f32 v44, v44
    v_exp_f32 v45, v45
    v_exp_f32 v46, v46
    v_smfmac_f32_32x32x32_bf16 v[68:83], v[20:23], v[36:43], v84
    ds_read_b128 v[32:35], v86 offset:3328
    buffer_load_dwordx4 v[228:231], v1, s[32:35], s48 offen offset:1024 sc1
    v_exp_f32 v47, v47
    v_exp_f32 v48, v48
    v_exp_f32 v49, v49
    v_exp_f32 v50, v50
    v_exp_f32 v51, v51
    v_exp_f32 v52, v52
    v_exp_f32 v53, v53
    v_smfmac_f32_32x32x32_bf16 v[68:83], v[24:27], v[44:51], v84
    s_waitcnt lgkmcnt(2)
    ds_read_b128 v[16:19], v85 offset:55296
    buffer_load_dwordx4 v[232:235], v1, s[32:35], s48 offen offset:2048 sc1
    v_exp_f32 v54, v54
    v_exp_f32 v55, v55
    v_exp_f32 v56, v56
    v_exp_f32 v57, v57
    v_mfma_f32_32x32x16_bf16 v[36:51], v[12:15], v[8:11], 0
    s_waitcnt lgkmcnt(1)
    ds_read_b128 v[20:23], v86 offset:5120
    v_exp_f32 v58, v58
    v_exp_f32 v59, v59
    v_exp_f32 v60, v60
    v_exp_f32 v61, v61
    v_exp_f32 v62, v62
    v_smfmac_f32_32x32x32_bf16 v[68:83], v[28:31], v[52:59], v84
    ds_read_b128 v[24:27], v86 offset:5376
    buffer_load_dwordx4 v[236:239], v1, s[32:35], s48 offen offset:3072 sc1
    v_exp_f32 v63, v63
    v_exp_f32 v64, v64
    v_exp_f32 v65, v65
    v_exp_f32 v66, v66
    v_exp_f32 v67, v67
    v_exp_f32 v36, v36
    v_exp_f32 v37, v37
    v_smfmac_f32_32x32x32_bf16 v[68:83], v[32:35], v[60:67], v84
    s_waitcnt lgkmcnt(2)
    ds_read_b128 v[12:15], v85 offset:57344
    v_exp_f32 v38, v38
    v_exp_f32 v39, v39
    v_exp_f32 v40, v40
    v_exp_f32 v41, v41
    v_mfma_f32_32x32x16_bf16 v[52:67], v[16:19], v[8:11], 0
    s_waitcnt lgkmcnt(1)
    ds_read_b128 v[28:31], v86 offset:7168
    v_exp_f32 v42, v42
    v_exp_f32 v43, v43
    v_exp_f32 v44, v44
    v_exp_f32 v45, v45
    v_exp_f32 v46, v46
    v_smfmac_f32_32x32x32_bf16 v[68:83], v[20:23], v[36:43], v84
    ds_read_b128 v[32:35], v86 offset:7424
    v_exp_f32 v47, v47
    v_exp_f32 v48, v48
    v_exp_f32 v49, v49
    v_exp_f32 v50, v50
    v_exp_f32 v51, v51
    v_exp_f32 v52, v52
    v_exp_f32 v53, v53
    v_smfmac_f32_32x32x32_bf16 v[68:83], v[24:27], v[44:51], v84
    s_waitcnt lgkmcnt(2)
    s_setprio 1
    ds_read_b128 v[16:19], v85 offset:59392
    v_exp_f32 v54, v54
    v_exp_f32 v55, v55
    v_exp_f32 v56, v56
    v_exp_f32 v57, v57
    v_mfma_f32_32x32x16_bf16 v[36:51], v[12:15], v[8:11], 0
    s_waitcnt lgkmcnt(1)
    v_add_u32 v86, v87, v86
    ds_read_b128 v[20:23], v86 offset:1024
    v_exp_f32 v58, v58
    v_exp_f32 v59, v59
    v_exp_f32 v60, v60
    v_exp_f32 v61, v61
    v_exp_f32 v62, v62
    v_smfmac_f32_32x32x32_bf16 v[68:83], v[28:31], v[52:59], v84
    ds_read_b128 v[24:27], v86 offset:1280
    v_exp_f32 v63, v63
    v_exp_f32 v64, v64
    v_exp_f32 v65, v65
    v_exp_f32 v66, v66
    v_exp_f32 v67, v67
    v_exp_f32 v36, v36
    v_exp_f32 v37, v37
    v_smfmac_f32_32x32x32_bf16 v[68:83], v[32:35], v[60:67], v84
    s_waitcnt lgkmcnt(2)
    ds_read_b128 v[12:15], v85 offset:61440
    buffer_load_dword v89, v88, s[32:35], 0 offen sc1
    v_exp_f32 v38, v38
    v_exp_f32 v39, v39
    v_exp_f32 v40, v40
    v_exp_f32 v41, v41
    v_mfma_f32_32x32x16_bf16 v[52:67], v[16:19], v[8:11], 0
    s_waitcnt lgkmcnt(1)
    ds_read_b128 v[28:31], v86 offset:3072
    v_exp_f32 v42, v42
    v_exp_f32 v43, v43
    v_exp_f32 v44, v44
    v_exp_f32 v45, v45
    v_exp_f32 v46, v46
    v_smfmac_f32_32x32x32_bf16 v[68:83], v[20:23], v[36:43], v84
    ds_read_b128 v[32:35], v86 offset:3328
    v_exp_f32 v47, v47
    v_exp_f32 v48, v48
    v_exp_f32 v49, v49
    v_exp_f32 v50, v50
    v_exp_f32 v51, v51
    v_exp_f32 v52, v52
    v_exp_f32 v53, v53
    v_smfmac_f32_32x32x32_bf16 v[68:83], v[24:27], v[44:51], v84
    s_waitcnt lgkmcnt(2)
    ds_read_b128 v[16:19], v85 offset:63488
    v_exp_f32 v54, v54
    v_exp_f32 v55, v55
    v_exp_f32 v56, v56
    v_exp_f32 v57, v57
    v_mfma_f32_32x32x16_bf16 v[36:51], v[12:15], v[8:11], 0
    s_waitcnt lgkmcnt(1)
    ds_read_b128 v[20:23], v86 offset:5120
    v_exp_f32 v58, v58
    v_exp_f32 v59, v59
    v_exp_f32 v60, v60
    v_exp_f32 v61, v61
    v_exp_f32 v62, v62
    v_smfmac_f32_32x32x32_bf16 v[68:83], v[28:31], v[52:59], v84
    ds_read_b128 v[24:27], v86 offset:5376
    v_exp_f32 v63, v63
    v_exp_f32 v64, v64
    v_exp_f32 v65, v65
    v_exp_f32 v66, v66
    v_exp_f32 v67, v67
    s_waitcnt vmcnt(0)
    v_cmp_ne_u32 vcc, v3, v89
    s_cbranch_vccnz R_f3
C_f3:
    v_exp_f32 v36, v36
    v_exp_f32 v37, v37
    v_smfmac_f32_32x32x32_bf16 v[68:83], v[32:35], v[60:67], v84
    s_waitcnt lgkmcnt(2)
    s_setprio 0
    s_lshl_b32 m0, s20, 12
    s_nop 0
    buffer_load_dwordx4 v1, s[32:35], s53 offen offset:0 sc1 lds
    v_exp_f32 v38, v38
    v_exp_f32 v39, v39
    v_exp_f32 v40, v40
    v_exp_f32 v41, v41
    v_mfma_f32_32x32x16_bf16 v[52:67], v[16:19], v[8:11], 0
    s_waitcnt lgkmcnt(0)
    ds_read_b128 v[28:31], v86 offset:7168
    v_exp_f32 v42, v42
    v_exp_f32 v43, v43
    v_exp_f32 v44, v44
    v_exp_f32 v45, v45
    v_exp_f32 v46, v46
    v_smfmac_f32_32x32x32_bf16 v[68:83], v[20:23], v[36:43], v84
    ds_read_b128 v[32:35], v86 offset:7424
    buffer_load_dwordx4 v1, s[32:35], s53 offen offset:1024 sc1 lds
    v_exp_f32 v47, v47
    v_exp_f32 v48, v48
    v_exp_f32 v49, v49
    v_exp_f32 v50, v50
    v_exp_f32 v51, v51
    v_exp_f32 v52, v52
    v_exp_f32 v53, v53
    v_smfmac_f32_32x32x32_bf16 v[68:83], v[24:27], v[44:51], v84
    buffer_load_dwordx4 v1, s[32:35], s53 offen offset:2048 sc1 lds
    v_exp_f32 v54, v54
    v_exp_f32 v55, v55
    v_exp_f32 v56, v56
    v_exp_f32 v57, v57
    v_exp_f32 v58, v58
    v_exp_f32 v59, v59
    v_exp_f32 v60, v60
    v_exp_f32 v61, v61
    v_exp_f32 v62, v62
    s_waitcnt lgkmcnt(0)
    v_smfmac_f32_32x32x32_bf16 v[68:83], v[28:31], v[52:59], v84
    buffer_load_dwordx4 v1, s[32:35], s53 offen offset:3072 sc1 lds
    v_exp_f32 v63, v63
    v_exp_f32 v64, v64
    v_exp_f32 v65, v65
    v_exp_f32 v66, v66
    v_exp_f32 v67, v67
    s_nop 1
    v_smfmac_f32_32x32x32_bf16 v[68:83], v[32:35], v[60:67], v84
    s_mov_b32 s28, s56
    s_mov_b32 s29, s57
    s_mov_b32 s30, 0x400000
    s_mov_b32 s31, 0x20000
    s_lshl_b32 s40, s19, 15
    v_add_u32 v5, s40, v1
    s_lshl_b32 s40, s18, 13
    s_add_u32 s40, s40, 32768
    v_add_u32 v6, s40, v1
    s_add_u32 s54, s52, 4096
    s_nop 1
    v_cmp_lt_f32 vcc, 0x21800000, v76
    s_mov_b64 s[66:67], vcc
    v_cmp_gt_f32 vcc, 0x5d800000, v76
    s_and_b64 s[66:67], s[66:67], vcc
    s_cmp_eq_u64 s[66:67], -1
    s_cbranch_scc0 K_slow
K_fin:
    v_rcp_f32 v92, v76
    s_nop 0
    v_mul_f32 v68, v68, v92
    v_mul_f32 v69, v69, v92
    v_mul_f32 v70, v70, v92
    v_mul_f32 v71, v71, v92
    v_mul_f32 v72, v72, v92
    v_mul_f32 v73, v73, v92
    v_mul_f32 v74, v74, v92
    v_mul_f32 v75, v75, v92
    v_cvt_pk_bf16_f32 v8, v68, v69
    v_cvt_pk_bf16_f32 v9, v70, v71
    v_cvt_pk_bf16_f32 v10, v72, v73
    v_cvt_pk_bf16_f32 v11, v74, v75
    buffer_store_dwordx4 v[8:11], v1, s[32:35], s51 offen sc1
    v_and_b32 v64, 31, v2
    v_lshlrev_b32 v64, 11, v64
    v_lshrrev_b32 v65, 5, v2
    v_lshl_add_u32 v64, v65, 4, v64
    s_lshl_b32 s44, s45, 16
    s_lshl_b32 s40, s46, 8
    s_add_u32 s44, s44, s40
    s_lshl_b32 s40, s18, 6
    s_add_u32 s44, s44, s40
    s_xor_b32 s40, s19, 1
    s_lshl_b32 s40, s40, 10
    s_add_u32 s44, s44, s40
    s_waitcnt vmcnt(1)
    s_barrier
    s_cmp_eq_u32 s19, 0
    s_cbranch_scc1 K_proj
    s_mov_b32 s65, 65536
    s_waitcnt vmcnt(0)
RL_oa:
    buffer_load_dwordx4 v[32:35], v1, s[32:35], s52 offen offset:0 sc1
    buffer_load_dwordx4 v[36:39], v1, s[32:35], s52 offen offset:1024 sc1
    buffer_load_dwordx4 v[40:43], v1, s[32:35], s52 offen offset:2048 sc1
    buffer_load_dwordx4 v[44:47], v1, s[32:35], s52 offen offset:3072 sc1
    buffer_load_dwordx4 v[48:51], v1, s[32:35], s54 offen offset:0 sc1
    buffer_load_dwordx4 v[52:55], v1, s[32:35], s54 offen offset:1024 sc1
    buffer_load_dwordx4 v[56:59], v1, s[32:35], s54 offen offset:2048 sc1
    buffer_load_dwordx4 v[60:63], v1, s[32:35], s54 offen offset:3072 sc1
    s_waitcnt vmcnt(0)
    s_sub_u32 s65, s65, 1
    s_cbranch_scc1 C_oa
    v_max3_u32 v67, v32, v33, v34
    v_max3_u32 v67, v67, v35, v36
    v_max3_u32 v67, v67, v37, v38
    v_max3_u32 v67, v67, v39, v40
    v_max3_u32 v67, v67, v41, v42
    v_max3_u32 v67, v67, v43, v44
    v_max3_u32 v67, v67, v45, v46
    v_max3_u32 v67, v67, v47, v48
    v_max3_u32 v67, v67, v49, v50
    v_max3_u32 v67, v67, v51, v52
    v_max3_u32 v67, v67, v53, v54
    v_max3_u32 v67, v67, v55, v56
    v_max3_u32 v67, v67, v57, v58
    v_max3_u32 v67, v67, v59, v60
    v_max3_u32 v67, v67, v61, v62
    v_max_u32 v67, v67, v63
    v_cmp_eq_u32 vcc, -1, v67
    s_cbranch_vccnz RL_oa
C_oa:
    ds_write_b128 v6, v[32:35] offset:0
    ds_write_b128 v6, v[36:39] offset:1024
    ds_write_b128 v6, v[40:43] offset:2048
    ds_write_b128 v6, v[44:47] offset:3072
    ds_write_b128 v6, v[48:51] offset:4096
    ds_write_b128 v6, v[52:55] offset:5120
    ds_write_b128 v6, v[56:59] offset:6144
    ds_write_b128 v6, v[60:63] offset:7168
    s_waitcnt lgkmcnt(0)
    s_barrier
K_proj:
    ds_read_b128 v[32:35], v5 offset:0
    ds_read_b128 v[36:39], v5 offset:1024
    ds_read_b128 v[40:43], v5 offset:2048
    ds_read_b128 v[44:47], v5 offset:3072
    ds_read_b128 v[48:51], v5 offset:4096
    ds_read_b128 v[52:55], v5 offset:5120
    ds_read_b128 v[56:59], v5 offset:6144
    ds_read_b128 v[60:63], v5 offset:7168
    s_waitcnt lgkmcnt(7)
    v_mfma_f32_32x32x16_bf16 v[16:31], v[112:115], v[32:35], 0
    ds_read_b128 v[32:35], v5 offset:8192
    s_waitcnt lgkmcnt(7)
    v_mfma_f32_32x32x16_bf16 v[16:31], v[116:119], v[36:39], v[16:31]
    ds_read_b128 v[36:39], v5 offset:9216
    s_waitcnt lgkmcnt(7)
    v_mfma_f32_32x32x16_bf16 v[16:31], v[120:123], v[40:43], v[16:31]
    ds_read_b128 v[40:43], v5 offset:10240
    s_waitcnt lgkmcnt(7)
    v_mfma_f32_32x32x16_bf16 v[16:31], v[124:127], v[44:47], v[16:31]
    ds_read_b128 v[44:47], v5 offset:11264
    s_waitcnt lgkmcnt(7)
    v_mfma_f32_32x32x16_bf16 v[16:31], v[128:131], v[48:51], v[16:31]
    ds_read_b128 v[48:51], v5 offset:12288
    s_waitcnt lgkmcnt(7)
    v_mfma_f32_32x32x16_bf16 v[16:31], v[132:135], v[52:55], v[16:31]
    ds_read_b128 v[52:55], v5 offset:13312
    s_waitcnt lgkmcnt(7)
    v_mfma_f32_32x32x16_bf16 v[16:31], v[136:139], v[56:59], v[16:31]
    ds_read_b128 v[56:59], v5 offset:14336
    s_waitcnt lgkmcnt(7)
    v_mfma_f32_32x32x16_bf16 v[16:31], v[140:143], v[60:63], v[16:31]
    ds_read_b128 v[60:63], v5 offset:15360
    s_waitcnt lgkmcnt(7)
    v_mfma_f32_32x32x16_bf16 v[16:31], v[144:147], v[32:35], v[16:31]
    ds_read_b128 v[32:35], v5 offset:16384
    s_waitcnt lgkmcnt(7)
    v_mfma_f32_32x32x16_bf16 v[16:31], v[148:151], v[36:39], v[16:31]
    ds_read_b128 v[36:39], v5 offset:17408
    s_waitcnt lgkmcnt(7)
    v_mfma_f32_32x32x16_bf16 v[16:31], v[152:155], v[40:43], v[16:31]
    ds_read_b128 v[40:43], v5 offset:18432
    s_waitcnt lgkmcnt(7)
    v_mfma_f32_32x32x16_bf16 v[16:31], v[156:159], v[44:47], v[16:31]
    ds_read_b128 v[44:47], v5 offset:19456
    s_waitcnt lgkmcnt(7)
    v_mfma_f32_32x32x16_bf16 v[16:31], v[160:163], v[48:51], v[16:31]
    ds_read_b128 v[48:51], v5 offset:20480
    s_waitcnt lgkmcnt(7)
    v_mfma_f32_32x32x16_bf16 v[16:31], v[164:167], v[52:55], v[16:31]
    ds_read_b128 v[52:55], v5 offset:21504
    s_waitcnt lgkmcnt(7)
    v_mfma_f32_32x32x16_bf16 v[16:31], v[168:171], v[56:59], v[16:31]
    ds_read_b128 v[56:59], v5 offset:22528
    s_waitcnt lgkmcnt(7)
    v_mfma_f32_32x32x16_bf16 v[16:31], v[172:175], v[60:63], v[16:31]
    ds_read_b128 v[60:63], v5 offset:23552
    s_waitcnt lgkmcnt(7)
    v_mfma_f32_32x32x16_bf16 v[16:31], v[176:179], v[32:35], v[16:31]
    ds_read_b128 v[32:35], v5 offset:24576
    s_waitcnt lgkmcnt(7)
    v_mfma_f32_32x32x16_bf16 v[16:31], v[180:183], v[36:39], v[16:31]
    ds_read_b128 v[36:39], v5 offset:25600
    s_waitcnt lgkmcnt(7)
    v_mfma_f32_32x32x16_bf16 v[16:31], v[184:187], v[40:43], v[16:31]
    ds_read_b128 v[40:43], v5 offset:26624
    s_waitcnt lgkmcnt(7)
    v_mfma_f32_32x32x16_bf16 v[16:31], v[188:191], v[44:47], v[16:31]
    ds_read_b128 v[44:47], v5 offset:27648
    s_waitcnt lgkmcnt(7)
    v_mfma_f32_32x32x16_bf16 v[16:31], v[192:195], v[48:51], v[16:31]
    ds_read_b128 v[48:51], v5 offset:28672
    s_waitcnt lgkmcnt(7)
    v_mfma_f32_32x32x16_bf16 v[16:31], v[196:199], v[52:55], v[16:31]
    ds_read_b128 v[52:55], v5 offset:29696
    s_waitcnt lgkmcnt(7)
    v_mfma_f32_32x32x16_bf16 v[16:31], v[200:203], v[56:59], v[16:31]
    ds_read_b128 v[56:59], v5 offset:30720
    s_waitcnt lgkmcnt(7)
    v_mfma_f32_32x32x16_bf16 v[16:31], v[204:207], v[60:63], v[16:31]
    ds_read_b128 v[60:63], v5 offset:31744
    s_waitcnt lgkmcnt(7)
    v_mfma_f32_32x32x16_bf16 v[16:31], v[208:211], v[32:35], v[16:31]
    s_waitcnt lgkmcnt(6)
    v_mfma_f32_32x32x16_bf16 v[16:31], v[212:215], v[36:39], v[16:31]
    s_waitcnt lgkmcnt(5)
    v_mfma_f32_32x32x16_bf16 v[16:31], v[216:219], v[40:43], v[16:31]
    s_waitcnt lgkmcnt(4)
    v_mfma_f32_32x32x16_bf16 v[16:31], v[220:223], v[44:47], v[16:31]
    s_waitcnt lgkmcnt(3)
    v_mfma_f32_32x32x16_bf16 v[16:31], v[224:227], v[48:51], v[16:31]
    s_waitcnt lgkmcnt(2)
    v_mfma_f32_32x32x16_bf16 v[16:31], v[228:231], v[52:55], v[16:31]
    s_waitcnt lgkmcnt(1)
    v_mfma_f32_32x32x16_bf16 v[16:31], v[232:235], v[56:59], v[16:31]
    s_waitcnt lgkmcnt(0)
    v_mfma_f32_32x32x16_bf16 v[16:31], v[236:239], v[60:63], v[16:31]
    s_nop 7
    s_nop 3
    v_cvt_pk_bf16_f32 v8, v16, v17
    v_cvt_pk_bf16_f32 v9, v18, v19
    v_cvt_pk_bf16_f32 v10, v20, v21
    v_cvt_pk_bf16_f32 v11, v22, v23
    v_cvt_pk_bf16_f32 v12, v24, v25
    v_cvt_pk_bf16_f32 v13, v26, v27
    v_cvt_pk_bf16_f32 v14, v28, v29
    v_cvt_pk_bf16_f32 v15, v30, v31
    s_nop 1
    v_permlane32_swap_b32 v8, v10
    v_permlane32_swap_b32 v9, v11
    v_permlane32_swap_b32 v12, v14
    v_permlane32_swap_b32 v13, v15
    s_cmp_lg_u32 s19, 0
    s_cbranch_scc1 K_st
    s_barrier
K_st:
    buffer_store_dwordx4 v[8:11], v64, s[28:31], s44 offen nt
    buffer_store_dwordx4 v[12:15], v64, s[28:31], s44 offen offset:32 nt
K_end:
    s_endpgm
K_bpre:
    s_load_dwordx2 s[36:37], s[0:1], 16
    s_load_dwordx2 s[12:13], s[0:1], 40
    s_mov_b32 s38, 0x80000
    s_mov_b32 s39, 0x20000
    s_mov_b32 s14, 0x80000
    s_mov_b32 s15, 0x20000
    s_bfe_u32 s40, s2, 0x50002
    s_and_b32 s41, s2, 3
    s_lshl_b32 s41, s41, 2
    s_add_u32 s41, s41, s18
    v_lshrrev_b32 v5, 5, v2
    v_and_b32 v6, 31, v2
    v_lshlrev_b32 v5, 12, v5
    v_lshl_add_u32 v5, v6, 1, v5
    s_lshl_b32 s48, s40, 14
    s_lshl_b32 s49, s41, 6
    s_add_u32 s48, s48, s49
    s_add_u32 s49, s48, 8192
    s_lshl_b32 s41, s41, 15
    s_lshl_b32 s40, s40, 10
    s_add_u32 s68, s41, s40
    s_add_u32 s68, s68, 14680064
    s_waitcnt lgkmcnt(0)
    buffer_load_ushort v16, v5, s[36:39], s48 offen offset:0
    buffer_load_ushort v17, v5, s[36:39], s48 offen offset:1024
    buffer_load_ushort v18, v5, s[36:39], s48 offen offset:2048
    buffer_load_ushort v19, v5, s[36:39], s48 offen offset:3072
    buffer_load_ushort v20, v5, s[36:39], s49 offen offset:0
    buffer_load_ushort v21, v5, s[36:39], s49 offen offset:1024
    buffer_load_ushort v22, v5, s[36:39], s49 offen offset:2048
    buffer_load_ushort v23, v5, s[36:39], s49 offen offset:3072
    buffer_load_ushort v24, v5, s[12:15], s48 offen offset:0
    buffer_load_ushort v25, v5, s[12:15], s48 offen offset:1024
    buffer_load_ushort v26, v5, s[12:15], s48 offen offset:2048
    buffer_load_ushort v27, v5, s[12:15], s48 offen offset:3072
    buffer_load_ushort v28, v5, s[12:15], s49 offen offset:0
    buffer_load_ushort v29, v5, s[12:15], s49 offen offset:1024
    buffer_load_ushort v30, v5, s[12:15], s49 offen offset:2048
    buffer_load_ushort v31, v5, s[12:15], s49 offen offset:3072
    s_waitcnt vmcnt(0)
    s_bfe_u32 s40, s2, 0x40003
    s_lshl_b32 s40, s40, 2
    s_add_u32 s40, s40, s18
    s_add_u32 s40, s40, 0
K_pfa:
    s_min_u32 s49, s40, 119
    s_mul_i32 s41, s49, 205
    s_lshr_b32 s41, s41, 12
    s_mul_i32 s48, s41, 20
    s_sub_u32 s48, s49, s48
    s_lshl_b32 s41, s41, 2
    s_lshr_b32 s41, 0x765432, s41
    s_and_b32 s41, s41, 7
    s_mul_i32 s49, s41, 196608
    s_lshr_b32 s50, s48, 2
    s_lshl_b32 s50, s50, 10
    s_add_u32 s49, s49, s50
    s_and_b32 s50, s48, 3
    s_lshl_b32 s50, s50, 7
    s_add_u32 s49, s49, s50
    s_and_b32 s50, s2, 1
    s_lshl_b32 s50, s50, 9
    s_add_u32 s49, s49, s50
    s_lshl_b32 s41, s41, 7
    s_sub_u32 s50, s48, 12
    s_lshl_b32 s50, s50, 16
    s_add_u32 s41, s41, s50
    s_bfe_u32 s50, s2, 0x20001
    s_lshl_b32 s50, s50, 19
    s_add_u32 s41, s41, s50
    s_movk_i32 s50, 3072
    s_mov_b32 s51, 0x180000
    s_cmp_lt_u32 s48, 12
    s_cselect_b32 s12, s6, s4
    s_cselect_b32 s13, s7, s5
    s_cselect_b32 s14, s51, 2097152
    s_cselect_b32 s41, s49, s41
    s_cselect_b32 s50, s50, 1024
    v_mul_u32_u24 v5, s50, v2
    buffer_load_dword v44, v5, s[12:15], s41 offen
    s_add_u32 s40, s40, 64
    s_cmp_lt_u32 s40, 64
    s_cbranch_scc1 K_pfa
    s_branch K_go
K_pf2:
    s_bfe_u32 s40, s2, 0x40003
    s_lshl_b32 s40, s40, 2
    s_add_u32 s40, s40, s18
    s_add_u32 s40, s40, 64
K_pfc:
    s_min_u32 s49, s40, 119
    s_mul_i32 s41, s49, 205
    s_lshr_b32 s41, s41, 12
    s_mul_i32 s48, s41, 20
    s_sub_u32 s48, s49, s48
    s_lshl_b32 s41, s41, 2
    s_lshr_b32 s41, 0x765432, s41
    s_and_b32 s41, s41, 7
    s_mul_i32 s49, s41, 196608
    s_lshr_b32 s50, s48, 2
    s_lshl_b32 s50, s50, 10
    s_add_u32 s49, s49, s50
    s_and_b32 s50, s48, 3
    s_lshl_b32 s50, s50, 7
    s_add_u32 s49, s49, s50
    s_and_b32 s50, s2, 1
    s_lshl_b32 s50, s50, 9
    s_add_u32 s49, s49, s50
    s_lshl_b32 s41, s41, 7
    s_sub_u32 s50, s48, 12
    s_lshl_b32 s50, s50, 16
    s_add_u32 s41, s41, s50
    s_bfe_u32 s50, s2, 0x20001
    s_lshl_b32 s50, s50, 19
    s_add_u32 s41, s41, s50
    s_movk_i32 s50, 3072
    s_mov_b32 s51, 0x180000
    s_cmp_lt_u32 s48, 12
    s_cselect_b32 s12, s6, s4
    s_cselect_b32 s13, s7, s5
    s_cselect_b32 s14, s51, 2097152
    s_cselect_b32 s41, s49, s41
    s_cselect_b32 s50, s50, 1024
    v_mul_u32_u24 v5, s50, v2
    buffer_load_dword v44, v5, s[12:15], s41 offen
    s_add_u32 s40, s40, 64
    s_cmp_lt_u32 s40, 128
    s_cbranch_scc1 K_pfc
    s_branch K_nopf2
K_early:
    s_mov_b32 s48, 1
    s_mov_b32 m0, s50
    buffer_load_dwordx4 v[8:11], v1, s[32:35], s51 offen sc1
    buffer_load_dwordx4 v1, s[32:35], s49 offen sc1 lds
    s_add_u32 m0, s50, 155648
    s_sub_u32 s51, s51, 4096
    buffer_load_dwordx4 v1, s[32:35], s51 offen sc1 lds
    s_mov_b32 m0, s50
    s_add_u32 m0, m0, 4096
    s_add_u32 s49, s49, 4096
    buffer_load_dwordx4 v1, s[32:35], s49 offen sc1 lds
    s_add_u32 m0, m0, 4096
    s_add_u32 s49, s49, 4096
    buffer_load_dwordx4 v1, s[32:35], s49 offen sc1 lds
    s_add_u32 m0, m0, 4096
    s_add_u32 s49, s49, 4096
    buffer_load_dwordx4 v1, s[32:35], s49 offen sc1 lds
    s_cmp_eq_u32 s41, 0
    s_cbranch_scc1 K_er0
    s_cmp_eq_u32 s41, 1
    s_cbranch_scc1 K_er1
    s_branch K_er2
R_tag:
    s_mov_b32 s65, 65536
RL_tag:
    buffer_load_dword v3, v91, s[36:39], 0 offen sc1
    s_waitcnt vmcnt(0)
    s_sub_u32 s65, s65, 1
    s_cbranch_scc1 C_tag
    v_cmp_eq_u32 vcc, 0, v3
    s_cbranch_vccnz RL_tag
    s_branch C_tag
K_pubB:
    s_add_u32 m0, m0, 8192
    s_add_u32 s43, s43, 8192
    s_add_u32 s40, s41, 155648
    v_add_u32 v5, s40, v1
    s_waitcnt lgkmcnt(0)
    s_barrier
    s_cmp_ge_u32 s20, 4
    s_cbranch_scc1 K_x0d
    ds_read_b128 v[8:11], v5
    s_branch K_x0d
R_f1:
    s_mov_b32 s65, 65536
RL_f1:
    buffer_load_dword v15, v14, s[32:35], 0 offen sc1
    s_waitcnt vmcnt(0)
    s_sub_u32 s65, s65, 1
    s_cbranch_scc1 C_f1
    v_cmp_ne_u32 vcc, v3, v15
    s_cbranch_vccnz RL_f1
    s_branch C_f1
R_f2:
    s_mov_b32 s65, 65536
RL_f2:
    buffer_load_dword v89, v88, s[32:35], 0 offen sc1
    s_waitcnt vmcnt(0)
    s_sub_u32 s65, s65, 1
    s_cbranch_scc1 C_f2
    v_cmp_ne_u32 vcc, v3, v89
    s_cbranch_vccnz RL_f2
    s_branch C_f2
R_f3:
    s_mov_b32 s65, 65536
RL_f3:
    buffer_load_dword v89, v88, s[32:35], 0 offen sc1
    s_waitcnt vmcnt(0)
    s_sub_u32 s65, s65, 1
    s_cbranch_scc1 C_f3
    v_cmp_ne_u32 vcc, v3, v89
    s_cbranch_vccnz RL_f3
    s_branch C_f3
K_slow:
    s_lshl_b32 s43, s60, 17
    s_add_u32 s43, s43, 2097152
    s_mov_b32 s44, s43
    s_mov_b32 s65, 64
    v_mov_b32 v92, 0xff800000
K_sl1:
    buffer_load_dwordx4 v[12:15], v1, s[32:35], s44 offen sc1
    s_add_u32 s44, s44, 2048
    s_waitcnt vmcnt(0)
    v_mfma_f32_32x32x16_bf16 v[36:51], v[12:15], v[8:11], 0
    s_nop 7
    s_nop 7
    v_max3_f32 v92, v92, v36, v37
    v_max3_f32 v92, v92, v38, v39
    v_max3_f32 v92, v92, v40, v41
    v_max3_f32 v92, v92, v42, v43
    v_max3_f32 v92, v92, v44, v45
    v_max3_f32 v92, v92, v46, v47
    v_max3_f32 v92, v92, v48, v49
    v_max3_f32 v92, v92, v50, v51
    s_sub_u32 s65, s65, 1
    s_cmp_lg_u32 s65, 0
    s_cbranch_scc1 K_sl1
    v_mov_b32 v93, v92
    s_nop 1
    v_permlane32_swap_b32 v92, v93
    s_nop 1
    v_max_f32 v92, v92, v93
    v_sub_f32 v96, 0, v92
    v_mov_b32 v68, 0
    v_sub_f32 v97, 0, v92
    v_mov_b32 v69, 0
    v_sub_f32 v98, 0, v92
    v_mov_b32 v70, 0
    v_sub_f32 v99, 0, v92
    v_mov_b32 v71, 0
    v_sub_f32 v100, 0, v92
    v_mov_b32 v72, 0
    v_sub_f32 v101, 0, v92
    v_mov_b32 v73, 0
    v_sub_f32 v102, 0, v92
    v_mov_b32 v74, 0
    v_sub_f32 v103, 0, v92
    v_mov_b32 v75, 0
    v_sub_f32 v104, 0, v92
    v_mov_b32 v76, 0
    v_sub_f32 v105, 0, v92
    v_mov_b32 v77, 0
    v_sub_f32 v106, 0, v92
    v_mov_b32 v78, 0
    v_sub_f32 v107, 0, v92
    v_mov_b32 v79, 0
    v_sub_f32 v108, 0, v92
    v_mov_b32 v80, 0
    v_sub_f32 v109, 0, v92
    v_mov_b32 v81, 0
    v_sub_f32 v110, 0, v92
    v_mov_b32 v82, 0
    v_sub_f32 v111, 0, v92
    v_mov_b32 v83, 0
    s_mov_b32 s65, 64
K_sl2:
    buffer_load_dwordx4 v[12:15], v1, s[32:35], s43 offen sc1
    s_mov_b64 exec, s[62:63]
    buffer_load_dwordx4 v[20:23], v1, s[32:35], s43 offen offset:1024 sc1
    buffer_load_dwordx4 v[24:27], v1, s[32:35], s43 offen offset:1280 sc1
    s_mov_b64 exec, -1
    s_add_u32 s43, s43, 2048
    s_waitcnt vmcnt(0)
    v_mfma_f32_32x32x16_bf16 v[36:51], v[12:15], v[8:11], v[96:111]
    s_nop 7
    s_nop 7
    v_exp_f32 v36, v36
    v_exp_f32 v37, v37
    v_exp_f32 v38, v38
    v_exp_f32 v39, v39
    v_exp_f32 v40, v40
    v_exp_f32 v41, v41
    v_exp_f32 v42, v42
    v_exp_f32 v43, v43
    v_exp_f32 v44, v44
    v_exp_f32 v45, v45
    v_exp_f32 v46, v46
    v_exp_f32 v47, v47
    v_exp_f32 v48, v48
    v_exp_f32 v49, v49
    v_exp_f32 v50, v50
    v_exp_f32 v51, v51
    s_nop 1
    v_smfmac_f32_32x32x32_bf16 v[68:83], v[20:23], v[36:43], v84
    v_smfmac_f32_32x32x32_bf16 v[68:83], v[24:27], v[44:51], v84
    s_sub_u32 s65, s65, 1
    s_cmp_lg_u32 s65, 0
    s_cbranch_scc1 K_sl2
    s_nop 7
    s_nop 7
    s_branch K_fin
.section .rodata,"a"
.p2align 6
.amdhsa_kernel concat_heads__softmax_full_mha__linear_attn_block__prompt_kernel
  .amdhsa_next_free_vgpr 248
  .amdhsa_next_free_sgpr 100
  .amdhsa_accum_offset 248
  .amdhsa_group_segment_fixed_size 0
  .amdhsa_kernarg_size 72
  .amdhsa_user_sgpr_count 2
  .amdhsa_user_sgpr_kernarg_segment_ptr 1
  .amdhsa_system_sgpr_workgroup_id_x 1
.end_amdhsa_kernel
```
